```python
import torch

def _softmax(x, axis=-1):
    return torch.softmax(x, dim=axis)
def _gelu(x):
    return torch.nn.functional.gelu(x, approximate="tanh")
def _silu(x):
    return torch.nn.functional.silu(x)
def _sigmoid(x):
    return torch.sigmoid(x)
def _layernorm(x, axis=-1, eps=1e-5):
    m = x.mean(dim=axis, keepdim=True)
    v = x.var(dim=axis, keepdim=True, unbiased=False)
    return (x - m) / torch.sqrt(v + eps)
def _scatter_add(tgt, idx, src, axis=0):
    return tgt.clone().index_add_(axis, idx, src)
def _segment_sum(src, seg, n):
    out = torch.zeros((n,) + src.shape[1:], dtype=src.dtype)
    return out.index_add_(0, seg, src)
def _pad(x, pw):
    flat = tuple(v for pair in reversed(pw) for v in pair)
    return torch.nn.functional.pad(x, flat)

kernel_name = 'standalone__mha_softmax__near_ridge'

def setup_inputs():

    _w = (lambda a: (lambda t: t.to(torch.bfloat16) if t.is_floating_point() else t)(torch.as_tensor(a)))
    B, H, Sq, Sk, D = 8, 32, 192, 512, 128
    return {
        "q": _w((lambda *s: torch.randn(*s, dtype=torch.bfloat16) * 0.8)(B, H, Sq, D)),
        "k": _w((lambda *s: torch.randn(*s, dtype=torch.bfloat16) * 0.8)(B, H, Sk, D)),
        "v": _w((lambda *s: torch.randn(*s, dtype=torch.bfloat16) * 0.05)(B, H, Sk, D)),
    }

def reference(q, k, v):
    scale = q.shape[-1] ** -0.5
    scores = torch.einsum("bhqd,bhkd->bhqk", q, k) * scale
    p = _softmax(scores, axis=-1)
    return torch.einsum("bhqk,bhkd->bhqd", p, v)
```

```asm
; @launch grid=(256,1,1) block=(256,1,1) lds=131072
.amdgcn_target "amdgcn-amd-amdhsa--gfx950"
.text
.globl standalone__mha_softmax__near_ridge_kernel
.p2align 12
.fill 3 * 64, 4, 0xbf800000
.p2align 8
.type standalone__mha_softmax__near_ridge_kernel,@function
standalone__mha_softmax__near_ridge_kernel:
    s_cmp_ge_u32 s2, 256
    s_cbranch_scc1 L_end
    s_load_dwordx2 s[16:17], s[0:1], 8
    s_load_dwordx2 s[12:13], s[0:1], 0
    s_load_dwordx2 s[20:21], s[0:1], 16
    s_load_dwordx2 s[24:25], s[0:1], 24
    v_lshrrev_b32 v150, 6, v0
    v_bfe_u32 v148, v0, 4, 2
    v_readfirstlane_b32 s34, v150
    v_and_b32 v149, 15, v0
    v_xor_b32 v151, v148, v149
    v_lshlrev_b32 v151, 4, v151
    v_lshl_add_u32 v124, v148, 8, v151
    v_lshlrev_b32 v152, 6, v150
    v_xor_b32 v244, v124, v152
    s_and_b32 s3, s2, 7
    s_lshl_b32 s3, s3, 5
    s_lshr_b32 s2, s2, 3
    s_add_u32 s3, s2, s3
    s_lshl_b32 s30, s34, 12
    s_lshl_b32 s29, s3, 17
    s_add_u32 s29, s29, s30
    s_mov_b32 s18, 33554432
    s_mov_b32 s19, 0x20000
    s_mov_b32 s14, 12582912
    s_mov_b32 s15, 0x20000
    s_mul_i32 s28, s3, 49152
    s_add_u32 s28, s28, s30
    v_xor_b32 v125, 64, v124
    v_xor_b32 v126, 128, v124
    v_xor_b32 v127, 192, v124
    s_getpc_b64 s[4:5]
L_pc:
    s_lshl_b32 s6, s2, 2
    s_add_u32 s6, s6, s34
    s_lshl_b32 s6, s6, 6
    s_add_u32 s10, s6, 0x2000
    s_add_u32 s11, s6, 0x4000
    s_min_u32 s11, s11, L_codeend-L_pc-4
    s_add_u32 m0, s30, 81920
    s_waitcnt lgkmcnt(0)
    s_load_dword s7, s[4:5], s6
    s_load_dword s8, s[4:5], s10
    s_load_dword s9, s[4:5], s11
    buffer_load_dwordx4 v124, s[12:15], s28 offen offset:0 nt lds
    buffer_load_dwordx4 v125, s[12:15], s28 offen offset:1024 nt lds
    buffer_load_dwordx4 v126, s[12:15], s28 offen offset:2048 nt lds
    buffer_load_dwordx4 v127, s[12:15], s28 offen offset:3072 nt lds
    s_mov_b32 m0, s30
    s_nop 0
    buffer_load_dwordx4 v244, s[16:19], s29 offen offset:0 nt lds
    buffer_load_dwordx4 v244, s[16:19], s29 offen offset:1024 nt lds
    s_barrier
    buffer_load_dwordx4 v244, s[16:19], s29 offen offset:2048 nt lds
    buffer_load_dwordx4 v244, s[16:19], s29 offen offset:3072 nt lds
    s_add_u32 m0, s30, 98304
    s_add_u32 s31, s28, 16384
    s_barrier
    buffer_load_dwordx4 v124, s[12:15], s31 offen offset:0 nt lds
    buffer_load_dwordx4 v125, s[12:15], s31 offen offset:1024 nt lds
    buffer_load_dwordx4 v126, s[12:15], s31 offen offset:2048 nt lds
    buffer_load_dwordx4 v127, s[12:15], s31 offen offset:3072 nt lds
    s_mov_b32 s22, 33554432
    s_mov_b32 s23, 0x20000
    s_mov_b32 s26, 12582912
    s_mov_b32 s27, 0x20000
    s_bfe_u32 s47, s3, 65536
    s_lshl_b32 s47, s47, 7
    s_add_u32 s32, s29, s47
    s_xor_b32 s33, s32, 128
    s_add_u32 s56, s28, s47
    s_add_u32 s57, s56, 16384
    s_add_u32 s58, s56, 32768
    s_xor_b32 s59, s56, 128
    s_xor_b32 s60, s57, 128
    s_xor_b32 s61, s58, 128
    v_and_b32 v153, 1, v150
    v_lshl_add_u32 v128, v149, 8, v151
    v_lshl_add_u32 v128, v150, 12, v128
    v_add_u32 v128, 0x10000, v128
    v_xor_b32 v129, 64, v128
    v_xor_b32 v130, 128, v128
    v_xor_b32 v131, 192, v128
    v_lshrrev_b32 v154, 2, v149
    v_and_b32 v155, 3, v149
    v_lshl_add_u32 v152, v154, 4, v155
    v_lshl_add_u32 v236, v152, 8, v151
    v_xor_b32 v237, 64, v236
    v_xor_b32 v238, 128, v236
    v_xor_b32 v239, 192, v236
    v_xor_b32 v240, 65536, v236
    v_xor_b32 v241, 65600, v236
    v_xor_b32 v242, 65664, v236
    v_xor_b32 v243, 65728, v236
    v_and_b32 v156, 1, v148
    v_lshrrev_b32 v152, 1, v154
    v_lshl_add_u32 v152, v156, 1, v152
    v_lshlrev_b32 v152, 5, v152
    v_lshl_add_u32 v152, v155, 3, v152
    v_lshl_add_u32 v152, v154, 7, v152
    v_lshl_add_u32 v228, v148, 12, v152
    v_xor_b32 v229, 32, v228
    v_xor_b32 v230, 64, v228
    v_xor_b32 v231, 96, v228
    v_xor_b32 v232, 65536, v228
    v_xor_b32 v233, 65568, v228
    v_xor_b32 v234, 65600, v228
    v_xor_b32 v235, 65632, v228
    v_lshrrev_b32 v151, 1, v148
    v_lshlrev_b32 v245, 14, v151
    v_and_b32 v152, 7, v149
    v_xor_b32 v151, v151, v152
    v_lshlrev_b32 v151, 4, v151
    v_lshl_add_u32 v151, v149, 7, v151
    v_lshl_add_u32 v151, v156, 3, v151
    v_lshl_add_u32 v247, v150, 14, v151
    v_xor_b32 v248, 32, v247
    v_xor_b32 v249, 64, v247
    v_xor_b32 v250, 96, v247
    v_bfe_u32 v151, v0, 3, 3
    v_lshlrev_b32 v252, 4, v152
    v_lshl_add_u32 v252, v151, 8, v252
    v_xor_b32 v152, v152, v151
    v_lshlrev_b32 v152, 4, v152
    v_lshl_add_u32 v152, v151, 7, v152
    v_lshl_add_u32 v251, v150, 14, v152
    v_lshl_add_u32 v152, v153, 1, v156
    v_lshlrev_b32 v152, 5, v152
    v_xor_b32 v152, v252, v152
    v_and_b32 v152, 0x3ff, v152
    v_or_b32 v245, v245, v152
    v_mov_b32 v151, 0x3f803f80
    v_accvgpr_write_b32 a248, v151
    v_accvgpr_write_b32 a249, v151
    v_accvgpr_write_b32 a250, v151
    v_accvgpr_write_b32 a251, v151
    v_cmp_gt_u32 vcc, 2, v155
    s_nop 1
    v_cndmask_b32 v151, 0, v151, vcc
    v_and_b32 v152, 1, v0
    v_mul_u32_u24 v152, 0xaaaa, v152
    v_or_b32 v152, 0x4444, v152
    v_lshl_or_b32 v246, v152, 16, v152
    v_accvgpr_write_b32 a252, v151
    v_accvgpr_write_b32 a253, v151
    v_accvgpr_write_b32 a254, v151
    v_accvgpr_write_b32 a255, v151
    v_mov_b32 v96, 0
    v_mov_b32 v97, 0
    v_mov_b32 v98, 0
    v_mov_b32 v99, 0
    v_mov_b32 v100, 0
    v_mov_b32 v101, 0
    v_mov_b32 v102, 0
    v_mov_b32 v103, 0
    v_mov_b32 v104, 0
    v_mov_b32 v105, 0
    v_mov_b32 v106, 0
    v_mov_b32 v107, 0
    s_mov_b32 s36, 0x3e0293ee
    s_mov_b32 s37, 0x3e0293ee
    s_waitcnt vmcnt(8)
    s_waitcnt lgkmcnt(0)
    ds_read_b128 v[108:111], v128 offset:16384
    ds_read_b128 v[112:115], v129 offset:16384
    ds_read_b128 v[116:119], v130 offset:16384
    ds_read_b128 v[120:123], v131 offset:16384
    s_add_u32 m0, s30, 16384
    s_add_u32 s31, s29, 16384
    buffer_load_dwordx4 v244, s[16:19], s31 offen offset:0 nt lds
    s_waitcnt lgkmcnt(3)
    v_lshlrev_b32 v132, 16, v108
    v_and_b32 v133, 0xffff0000, v108
    v_lshlrev_b32 v134, 16, v109
    v_and_b32 v135, 0xffff0000, v109
    v_lshlrev_b32 v136, 16, v110
    v_and_b32 v137, 0xffff0000, v110
    v_lshlrev_b32 v138, 16, v111
    v_and_b32 v139, 0xffff0000, v111
    v_pk_mul_f32 v[132:133], v[132:133], s[36:37]
    v_pk_mul_f32 v[134:135], v[134:135], s[36:37]
    v_pk_mul_f32 v[136:137], v[136:137], s[36:37]
    v_pk_mul_f32 v[138:139], v[138:139], s[36:37]
    v_cvt_pk_bf16_f32 v132, v132, v133
    v_cvt_pk_bf16_f32 v134, v134, v135
    v_cvt_pk_bf16_f32 v136, v136, v137
    v_cvt_pk_bf16_f32 v138, v138, v139
    v_accvgpr_write_b32 a0, v132
    v_accvgpr_write_b32 a1, v134
    v_accvgpr_write_b32 a2, v136
    v_accvgpr_write_b32 a3, v138
    s_waitcnt lgkmcnt(2)
    v_lshlrev_b32 v132, 16, v112
    v_and_b32 v133, 0xffff0000, v112
    v_lshlrev_b32 v134, 16, v113
    v_and_b32 v135, 0xffff0000, v113
    v_lshlrev_b32 v136, 16, v114
    v_and_b32 v137, 0xffff0000, v114
    v_lshlrev_b32 v138, 16, v115
    v_and_b32 v139, 0xffff0000, v115
    v_pk_mul_f32 v[132:133], v[132:133], s[36:37]
    v_pk_mul_f32 v[134:135], v[134:135], s[36:37]
    v_pk_mul_f32 v[136:137], v[136:137], s[36:37]
    v_pk_mul_f32 v[138:139], v[138:139], s[36:37]
    v_cvt_pk_bf16_f32 v132, v132, v133
    v_cvt_pk_bf16_f32 v134, v134, v135
    v_cvt_pk_bf16_f32 v136, v136, v137
    v_cvt_pk_bf16_f32 v138, v138, v139
    v_accvgpr_write_b32 a4, v132
    v_accvgpr_write_b32 a5, v134
    v_accvgpr_write_b32 a6, v136
    v_accvgpr_write_b32 a7, v138
    buffer_load_dwordx4 v244, s[16:19], s31 offen offset:1024 nt lds
    s_waitcnt lgkmcnt(1)
    v_lshlrev_b32 v132, 16, v116
    v_and_b32 v133, 0xffff0000, v116
    v_lshlrev_b32 v134, 16, v117
    v_and_b32 v135, 0xffff0000, v117
    v_lshlrev_b32 v136, 16, v118
    v_and_b32 v137, 0xffff0000, v118
    v_lshlrev_b32 v138, 16, v119
    v_and_b32 v139, 0xffff0000, v119
    v_pk_mul_f32 v[132:133], v[132:133], s[36:37]
    v_pk_mul_f32 v[134:135], v[134:135], s[36:37]
    v_pk_mul_f32 v[136:137], v[136:137], s[36:37]
    v_pk_mul_f32 v[138:139], v[138:139], s[36:37]
    v_cvt_pk_bf16_f32 v132, v132, v133
    v_cvt_pk_bf16_f32 v134, v134, v135
    v_cvt_pk_bf16_f32 v136, v136, v137
    v_cvt_pk_bf16_f32 v138, v138, v139
    v_accvgpr_write_b32 a8, v132
    v_accvgpr_write_b32 a9, v134
    v_accvgpr_write_b32 a10, v136
    v_accvgpr_write_b32 a11, v138
    s_waitcnt lgkmcnt(0)
    v_lshlrev_b32 v132, 16, v120
    v_and_b32 v133, 0xffff0000, v120
    v_lshlrev_b32 v134, 16, v121
    v_and_b32 v135, 0xffff0000, v121
    v_lshlrev_b32 v136, 16, v122
    v_and_b32 v137, 0xffff0000, v122
    v_lshlrev_b32 v138, 16, v123
    v_and_b32 v139, 0xffff0000, v123
    v_pk_mul_f32 v[132:133], v[132:133], s[36:37]
    v_pk_mul_f32 v[134:135], v[134:135], s[36:37]
    v_pk_mul_f32 v[136:137], v[136:137], s[36:37]
    v_pk_mul_f32 v[138:139], v[138:139], s[36:37]
    v_cvt_pk_bf16_f32 v132, v132, v133
    v_cvt_pk_bf16_f32 v134, v134, v135
    v_cvt_pk_bf16_f32 v136, v136, v137
    v_cvt_pk_bf16_f32 v138, v138, v139
    v_accvgpr_write_b32 a12, v132
    v_accvgpr_write_b32 a13, v134
    v_accvgpr_write_b32 a14, v136
    v_accvgpr_write_b32 a15, v138
    s_waitcnt vmcnt(8)
    s_barrier
    ds_read_b128 a[48:51], v236 offset:0
    ds_read_b128 a[52:55], v237 offset:0
    ds_read_b128 a[56:59], v238 offset:0
    ds_read_b128 a[60:63], v239 offset:0
    ds_read_b128 a[64:67], v236 offset:1024
    ds_read_b128 a[68:71], v237 offset:1024
    ds_read_b128 a[72:75], v238 offset:1024
    ds_read_b128 a[76:79], v239 offset:1024
    buffer_load_dwordx4 v244, s[16:19], s31 offen offset:2048 nt lds
    s_waitcnt lgkmcnt(4)
    v_mfma_f32_16x16x32_bf16 v[56:59], a[48:51], a[0:3], 0
    v_mfma_f32_16x16x32_bf16 v[56:59], a[52:55], a[4:7], v[56:59]
    v_mfma_f32_16x16x32_bf16 v[56:59], a[56:59], a[8:11], v[56:59]
    v_mfma_f32_16x16x32_bf16 v[56:59], a[60:63], a[12:15], v[56:59]
    s_waitcnt lgkmcnt(0)
    v_mfma_f32_16x16x32_bf16 v[60:63], a[76:79], a[12:15], 0
    s_nop 2
    v_mfma_f32_16x16x32_bf16 v[60:63], a[72:75], a[8:11], v[60:63]
    s_nop 1
    v_mfma_f32_16x16x32_bf16 v[60:63], a[68:71], a[4:7], v[60:63]
    v_exp_f32 v56, v56
    v_mfma_f32_16x16x32_bf16 v[60:63], a[64:67], a[0:3], v[60:63]
    v_exp_f32 v57, v57
    v_exp_f32 v58, v58
    v_exp_f32 v59, v59
    v_cvt_pk_bf16_f32 v56, v56, v57
    v_cvt_pk_bf16_f32 v58, v58, v59
    v_accvgpr_write_b32 a176, v56
    v_accvgpr_write_b32 a177, v58
    s_nop 0
    v_exp_f32 v60, v60
    v_exp_f32 v61, v61
    v_exp_f32 v62, v62
    v_exp_f32 v63, v63
    v_cvt_pk_bf16_f32 v60, v60, v61
    v_cvt_pk_bf16_f32 v62, v62, v63
    v_accvgpr_write_b32 a178, v60
    v_accvgpr_write_b32 a179, v62
    buffer_load_dwordx4 v244, s[16:19], s31 offen offset:3072 nt lds
    s_waitcnt vmcnt(8)
    s_barrier
    ds_read_b128 a[80:83], v236 offset:2048
    ds_read_b128 a[84:87], v237 offset:2048
    ds_read_b128 a[88:91], v238 offset:2048
    ds_read_b128 a[92:95], v239 offset:2048
    ds_read_b128 a[96:99], v236 offset:3072
    ds_read_b128 a[100:103], v237 offset:3072
    ds_read_b128 a[104:107], v238 offset:3072
    ds_read_b128 a[108:111], v239 offset:3072
    s_add_u32 m0, s30, 114688
    s_add_u32 s31, s28, 32768
    buffer_load_dwordx4 v124, s[12:15], s31 offen offset:0 nt lds
    s_waitcnt lgkmcnt(4)
    v_mfma_f32_16x16x32_bf16 v[80:83], a[80:83], a[0:3], 0
    v_mfma_f32_16x16x32_bf16 v[80:83], a[84:87], a[4:7], v[80:83]
    v_mfma_f32_16x16x32_bf16 v[80:83], a[88:91], a[8:11], v[80:83]
    v_mfma_f32_16x16x32_bf16 v[80:83], a[92:95], a[12:15], v[80:83]
    s_waitcnt lgkmcnt(0)
    v_mfma_f32_16x16x32_bf16 v[84:87], a[108:111], a[12:15], 0
    s_nop 2
    v_mfma_f32_16x16x32_bf16 v[84:87], a[104:107], a[8:11], v[84:87]
    s_nop 1
    v_mfma_f32_16x16x32_bf16 v[84:87], a[100:103], a[4:7], v[84:87]
    v_exp_f32 v80, v80
    v_mfma_f32_16x16x32_bf16 v[84:87], a[96:99], a[0:3], v[84:87]
    v_exp_f32 v81, v81
    v_exp_f32 v82, v82
    v_exp_f32 v83, v83
    v_cvt_pk_bf16_f32 v80, v80, v81
    v_cvt_pk_bf16_f32 v82, v82, v83
    v_accvgpr_write_b32 a180, v80
    v_accvgpr_write_b32 a181, v82
    s_nop 0
    v_exp_f32 v84, v84
    v_exp_f32 v85, v85
    v_exp_f32 v86, v86
    v_exp_f32 v87, v87
    v_cvt_pk_bf16_f32 v84, v84, v85
    v_cvt_pk_bf16_f32 v86, v86, v87
    v_accvgpr_write_b32 a182, v84
    v_accvgpr_write_b32 a183, v86
    buffer_load_dwordx4 v125, s[12:15], s31 offen offset:1024 nt lds
    buffer_load_dwordx4 v126, s[12:15], s31 offen offset:2048 nt lds
    buffer_load_dwordx4 v127, s[12:15], s31 offen offset:3072 nt lds
    s_cmp_eq_u32 s34, 0
    s_cbranch_scc1 L_stub0
    s_cmp_eq_u32 s34, 1
    s_cbranch_scc1 L_stub1
    s_cmp_eq_u32 s34, 2
    s_cbranch_scc1 L_stub2
L_ret:
    s_cmp_lg_u32 s3, s3
    s_waitcnt vmcnt(8)
    ds_read_b128 v[108:111], v128 offset:32768
    ds_read_b128 v[112:115], v129 offset:32768
    ds_read_b128 v[116:119], v130 offset:32768
    ds_read_b128 v[120:123], v131 offset:32768
    s_add_u32 m0, s30, 32768
    s_add_u32 s31, s29, 32768
    buffer_load_dwordx4 v244, s[16:19], s31 offen offset:0 nt lds
    s_waitcnt lgkmcnt(3)
    v_lshlrev_b32 v132, 16, v108
    v_and_b32 v133, 0xffff0000, v108
    v_lshlrev_b32 v134, 16, v109
    v_and_b32 v135, 0xffff0000, v109
    v_lshlrev_b32 v136, 16, v110
    v_and_b32 v137, 0xffff0000, v110
    v_lshlrev_b32 v138, 16, v111
    v_and_b32 v139, 0xffff0000, v111
    v_pk_mul_f32 v[132:133], v[132:133], s[36:37]
    v_pk_mul_f32 v[134:135], v[134:135], s[36:37]
    v_pk_mul_f32 v[136:137], v[136:137], s[36:37]
    v_pk_mul_f32 v[138:139], v[138:139], s[36:37]
    v_cvt_pk_bf16_f32 v132, v132, v133
    v_cvt_pk_bf16_f32 v134, v134, v135
    v_cvt_pk_bf16_f32 v136, v136, v137
    v_cvt_pk_bf16_f32 v138, v138, v139
    v_accvgpr_write_b32 a16, v132
    v_accvgpr_write_b32 a17, v134
    v_accvgpr_write_b32 a18, v136
    v_accvgpr_write_b32 a19, v138
    s_waitcnt lgkmcnt(2)
    v_lshlrev_b32 v132, 16, v112
    v_and_b32 v133, 0xffff0000, v112
    v_lshlrev_b32 v134, 16, v113
    v_and_b32 v135, 0xffff0000, v113
    v_lshlrev_b32 v136, 16, v114
    v_and_b32 v137, 0xffff0000, v114
    v_lshlrev_b32 v138, 16, v115
    v_and_b32 v139, 0xffff0000, v115
    v_pk_mul_f32 v[132:133], v[132:133], s[36:37]
    v_pk_mul_f32 v[134:135], v[134:135], s[36:37]
    v_pk_mul_f32 v[136:137], v[136:137], s[36:37]
    v_pk_mul_f32 v[138:139], v[138:139], s[36:37]
    v_cvt_pk_bf16_f32 v132, v132, v133
    v_cvt_pk_bf16_f32 v134, v134, v135
    v_cvt_pk_bf16_f32 v136, v136, v137
    v_cvt_pk_bf16_f32 v138, v138, v139
    v_accvgpr_write_b32 a20, v132
    v_accvgpr_write_b32 a21, v134
    v_accvgpr_write_b32 a22, v136
    v_accvgpr_write_b32 a23, v138
    buffer_load_dwordx4 v244, s[16:19], s31 offen offset:1024 nt lds
    s_waitcnt lgkmcnt(1)
    v_lshlrev_b32 v132, 16, v116
    v_and_b32 v133, 0xffff0000, v116
    v_lshlrev_b32 v134, 16, v117
    v_and_b32 v135, 0xffff0000, v117
    v_lshlrev_b32 v136, 16, v118
    v_and_b32 v137, 0xffff0000, v118
    v_lshlrev_b32 v138, 16, v119
    v_and_b32 v139, 0xffff0000, v119
    v_pk_mul_f32 v[132:133], v[132:133], s[36:37]
    v_pk_mul_f32 v[134:135], v[134:135], s[36:37]
    v_pk_mul_f32 v[136:137], v[136:137], s[36:37]
    v_pk_mul_f32 v[138:139], v[138:139], s[36:37]
    v_cvt_pk_bf16_f32 v132, v132, v133
    v_cvt_pk_bf16_f32 v134, v134, v135
    v_cvt_pk_bf16_f32 v136, v136, v137
    v_cvt_pk_bf16_f32 v138, v138, v139
    v_accvgpr_write_b32 a24, v132
    v_accvgpr_write_b32 a25, v134
    v_accvgpr_write_b32 a26, v136
    v_accvgpr_write_b32 a27, v138
    s_waitcnt lgkmcnt(0)
    v_lshlrev_b32 v132, 16, v120
    v_and_b32 v133, 0xffff0000, v120
    v_lshlrev_b32 v134, 16, v121
    v_and_b32 v135, 0xffff0000, v121
    v_lshlrev_b32 v136, 16, v122
    v_and_b32 v137, 0xffff0000, v122
    v_lshlrev_b32 v138, 16, v123
    v_and_b32 v139, 0xffff0000, v123
    v_pk_mul_f32 v[132:133], v[132:133], s[36:37]
    v_pk_mul_f32 v[134:135], v[134:135], s[36:37]
    v_pk_mul_f32 v[136:137], v[136:137], s[36:37]
    v_pk_mul_f32 v[138:139], v[138:139], s[36:37]
    v_cvt_pk_bf16_f32 v132, v132, v133
    v_cvt_pk_bf16_f32 v134, v134, v135
    v_cvt_pk_bf16_f32 v136, v136, v137
    v_cvt_pk_bf16_f32 v138, v138, v139
    v_accvgpr_write_b32 a28, v132
    v_accvgpr_write_b32 a29, v134
    v_accvgpr_write_b32 a30, v136
    v_accvgpr_write_b32 a31, v138
    v_mfma_f32_16x16x32_bf16 v[52:55], a[48:51], a[16:19], 0
    buffer_load_dwordx4 v244, s[16:19], s31 offen offset:2048 nt lds
    v_mfma_f32_16x16x32_bf16 v[52:55], a[52:55], a[20:23], v[52:55]
    v_mfma_f32_16x16x32_bf16 v[52:55], a[56:59], a[24:27], v[52:55]
    v_mfma_f32_16x16x32_bf16 v[52:55], a[60:63], a[28:31], v[52:55]
    v_mfma_f32_16x16x32_bf16 v[64:67], a[76:79], a[28:31], 0
    s_nop 2
    v_mfma_f32_16x16x32_bf16 v[64:67], a[72:75], a[24:27], v[64:67]
    s_nop 2
    v_mfma_f32_16x16x32_bf16 v[64:67], a[68:71], a[20:23], v[64:67]
    v_exp_f32 v52, v52
    v_mfma_f32_16x16x32_bf16 v[64:67], a[64:67], a[16:19], v[64:67]
    v_exp_f32 v53, v53
    v_mfma_f32_16x16x32_bf16 v[76:79], a[80:83], a[16:19], 0
    v_exp_f32 v54, v54
    v_mfma_f32_16x16x32_bf16 v[76:79], a[84:87], a[20:23], v[76:79]
    v_exp_f32 v55, v55
    v_cvt_pk_bf16_f32 v52, v52, v53
    v_mfma_f32_16x16x32_bf16 v[76:79], a[88:91], a[24:27], v[76:79]
    v_cvt_pk_bf16_f32 v54, v54, v55
    v_accvgpr_write_b32 a184, v52
    v_mfma_f32_16x16x32_bf16 v[76:79], a[92:95], a[28:31], v[76:79]
    v_accvgpr_write_b32 a185, v54
    v_exp_f32 v64, v64
    v_mfma_f32_16x16x32_bf16 v[88:91], a[108:111], a[28:31], 0
    v_exp_f32 v65, v65
    v_mfma_f32_16x16x32_bf16 v[88:91], a[104:107], a[24:27], v[88:91]
    v_exp_f32 v66, v66
    v_cvt_pk_bf16_f32 v64, v64, v65
    v_mfma_f32_16x16x32_bf16 v[88:91], a[100:103], a[20:23], v[88:91]
    v_exp_f32 v67, v67
    v_mfma_f32_16x16x32_bf16 v[88:91], a[96:99], a[16:19], v[88:91]
    v_cvt_pk_bf16_f32 v66, v66, v67
    v_accvgpr_write_b32 a186, v64
    v_accvgpr_write_b32 a187, v66
    v_exp_f32 v76, v76
    v_exp_f32 v77, v77
    v_exp_f32 v78, v78
    v_exp_f32 v79, v79
    v_cvt_pk_bf16_f32 v76, v76, v77
    v_cvt_pk_bf16_f32 v78, v78, v79
    v_accvgpr_write_b32 a188, v76
    v_accvgpr_write_b32 a189, v78
    v_exp_f32 v88, v88
    v_exp_f32 v89, v89
    v_exp_f32 v90, v90
    v_exp_f32 v91, v91
    v_cvt_pk_bf16_f32 v88, v88, v89
    v_cvt_pk_bf16_f32 v90, v90, v91
    v_accvgpr_write_b32 a190, v88
    v_accvgpr_write_b32 a191, v90
    s_waitcnt vmcnt(9)
    s_barrier
    ds_read_b128 a[112:115], v236 offset:16384
    ds_read_b128 a[116:119], v237 offset:16384
    ds_read_b128 a[120:123], v238 offset:16384
    ds_read_b128 a[124:127], v239 offset:16384
    ds_read_b128 a[128:131], v236 offset:17408
    ds_read_b128 a[132:135], v237 offset:17408
    ds_read_b128 a[136:139], v238 offset:17408
    ds_read_b128 a[140:143], v239 offset:17408
    s_waitcnt lgkmcnt(4)
    v_mfma_f32_16x16x32_bf16 v[8:11], a[112:115], a[0:3], 0
    v_mfma_f32_16x16x32_bf16 v[8:11], a[116:119], a[4:7], v[8:11]
    v_mfma_f32_16x16x32_bf16 v[8:11], a[120:123], a[8:11], v[8:11]
    v_mfma_f32_16x16x32_bf16 v[8:11], a[124:127], a[12:15], v[8:11]
    v_mfma_f32_16x16x32_bf16 v[4:7], a[124:127], a[28:31], 0
    s_nop 2
    v_mfma_f32_16x16x32_bf16 v[4:7], a[120:123], a[24:27], v[4:7]
    s_nop 2
    v_mfma_f32_16x16x32_bf16 v[4:7], a[116:119], a[20:23], v[4:7]
    v_exp_f32 v8, v8
    v_mfma_f32_16x16x32_bf16 v[4:7], a[112:115], a[16:19], v[4:7]
    s_waitcnt lgkmcnt(0)
    v_exp_f32 v9, v9
    v_mfma_f32_16x16x32_bf16 v[16:19], a[128:131], a[16:19], 0
    v_exp_f32 v10, v10
    v_mfma_f32_16x16x32_bf16 v[16:19], a[132:135], a[20:23], v[16:19]
    v_exp_f32 v11, v11
    v_cvt_pk_bf16_f32 v8, v8, v9
    v_mfma_f32_16x16x32_bf16 v[16:19], a[136:139], a[24:27], v[16:19]
    v_exp_f32 v4, v4
    v_mfma_f32_16x16x32_bf16 v[16:19], a[140:143], a[28:31], v[16:19]
    v_exp_f32 v5, v5
    v_cvt_pk_bf16_f32 v10, v10, v11
    v_mfma_f32_16x16x32_bf16 v[12:15], a[140:143], a[12:15], 0
    v_exp_f32 v6, v6
    v_mfma_f32_16x16x32_bf16 v[12:15], a[136:139], a[8:11], v[12:15]
    v_exp_f32 v7, v7
    v_cvt_pk_bf16_f32 v4, v4, v5
    v_mfma_f32_16x16x32_bf16 v[12:15], a[132:135], a[4:7], v[12:15]
    v_cvt_pk_bf16_f32 v6, v6, v7
    v_accvgpr_write_b32 a208, v4
    v_mfma_f32_16x16x32_bf16 v[12:15], a[128:131], a[0:3], v[12:15]
    v_accvgpr_write_b32 a209, v6
    v_accvgpr_write_b32 a200, v8
    v_accvgpr_write_b32 a201, v10
    v_exp_f32 v16, v16
    v_exp_f32 v17, v17
    v_exp_f32 v18, v18
    v_exp_f32 v19, v19
    v_cvt_pk_bf16_f32 v16, v16, v17
    v_cvt_pk_bf16_f32 v18, v18, v19
    v_accvgpr_write_b32 a210, v16
    v_accvgpr_write_b32 a211, v18
    v_exp_f32 v12, v12
    v_exp_f32 v13, v13
    v_exp_f32 v14, v14
    v_exp_f32 v15, v15
    v_cvt_pk_bf16_f32 v12, v12, v13
    v_cvt_pk_bf16_f32 v14, v14, v15
    v_accvgpr_write_b32 a202, v12
    v_accvgpr_write_b32 a203, v14
    s_waitcnt vmcnt(7)
    s_barrier
    ds_read_b128 a[144:147], v236 offset:18432
    ds_read_b128 a[148:151], v237 offset:18432
    ds_read_b128 a[152:155], v238 offset:18432
    ds_read_b128 a[156:159], v239 offset:18432
    ds_read_b128 a[160:163], v236 offset:19456
    ds_read_b128 a[164:167], v237 offset:19456
    ds_read_b128 a[168:171], v238 offset:19456
    ds_read_b128 a[172:175], v239 offset:19456
    buffer_load_dwordx4 v244, s[16:19], s31 offen offset:3072 nt lds
    s_waitcnt lgkmcnt(4)
    v_mfma_f32_16x16x32_bf16 v[32:35], a[144:147], a[0:3], 0
    v_mfma_f32_16x16x32_bf16 v[32:35], a[148:151], a[4:7], v[32:35]
    v_mfma_f32_16x16x32_bf16 v[32:35], a[152:155], a[8:11], v[32:35]
    v_mfma_f32_16x16x32_bf16 v[32:35], a[156:159], a[12:15], v[32:35]
    v_mfma_f32_16x16x32_bf16 v[28:31], a[156:159], a[28:31], 0
    s_nop 2
    v_mfma_f32_16x16x32_bf16 v[28:31], a[152:155], a[24:27], v[28:31]
    s_nop 2
    v_mfma_f32_16x16x32_bf16 v[28:31], a[148:151], a[20:23], v[28:31]
    v_exp_f32 v32, v32
    v_mfma_f32_16x16x32_bf16 v[28:31], a[144:147], a[16:19], v[28:31]
    s_waitcnt lgkmcnt(0)
    v_exp_f32 v33, v33
    v_mfma_f32_16x16x32_bf16 v[40:43], a[160:163], a[16:19], 0
    v_exp_f32 v34, v34
    v_mfma_f32_16x16x32_bf16 v[40:43], a[164:167], a[20:23], v[40:43]
    v_exp_f32 v35, v35
    v_cvt_pk_bf16_f32 v32, v32, v33
    v_mfma_f32_16x16x32_bf16 v[40:43], a[168:171], a[24:27], v[40:43]
    v_exp_f32 v28, v28
    v_mfma_f32_16x16x32_bf16 v[40:43], a[172:175], a[28:31], v[40:43]
    v_exp_f32 v29, v29
    v_cvt_pk_bf16_f32 v34, v34, v35
    v_mfma_f32_16x16x32_bf16 v[36:39], a[172:175], a[12:15], 0
    v_exp_f32 v30, v30
    v_mfma_f32_16x16x32_bf16 v[36:39], a[168:171], a[8:11], v[36:39]
    v_exp_f32 v31, v31
    v_cvt_pk_bf16_f32 v28, v28, v29
    v_mfma_f32_16x16x32_bf16 v[36:39], a[164:167], a[4:7], v[36:39]
    v_cvt_pk_bf16_f32 v30, v30, v31
    v_accvgpr_write_b32 a212, v28
    v_mfma_f32_16x16x32_bf16 v[36:39], a[160:163], a[0:3], v[36:39]
    v_accvgpr_write_b32 a213, v30
    v_accvgpr_write_b32 a204, v32
    v_accvgpr_write_b32 a205, v34
    v_exp_f32 v40, v40
    v_exp_f32 v41, v41
    v_exp_f32 v42, v42
    v_exp_f32 v43, v43
    v_cvt_pk_bf16_f32 v40, v40, v41
    v_cvt_pk_bf16_f32 v42, v42, v43
    v_accvgpr_write_b32 a214, v40
    v_accvgpr_write_b32 a215, v42
    v_exp_f32 v36, v36
    v_exp_f32 v37, v37
    v_exp_f32 v38, v38
    v_exp_f32 v39, v39
    v_cvt_pk_bf16_f32 v36, v36, v37
    v_cvt_pk_bf16_f32 v38, v38, v39
    v_accvgpr_write_b32 a206, v36
    v_accvgpr_write_b32 a207, v38
    s_add_u32 m0, s30, 49152
    s_add_u32 s31, s29, 49152
    buffer_load_dwordx4 v244, s[16:19], s31 offen offset:0 nt lds
    s_waitcnt vmcnt(5)
    ds_read_b128 v[108:111], v128 offset:49152
    ds_read_b128 v[112:115], v129 offset:49152
    ds_read_b128 v[116:119], v130 offset:49152
    ds_read_b128 v[120:123], v131 offset:49152
    buffer_load_dwordx4 v244, s[16:19], s31 offen offset:1024 nt lds
    s_waitcnt lgkmcnt(3)
    v_lshlrev_b32 v132, 16, v108
    v_and_b32 v133, 0xffff0000, v108
    v_lshlrev_b32 v134, 16, v109
    v_and_b32 v135, 0xffff0000, v109
    v_lshlrev_b32 v136, 16, v110
    v_and_b32 v137, 0xffff0000, v110
    v_lshlrev_b32 v138, 16, v111
    v_and_b32 v139, 0xffff0000, v111
    v_pk_mul_f32 v[132:133], v[132:133], s[36:37]
    v_pk_mul_f32 v[134:135], v[134:135], s[36:37]
    v_pk_mul_f32 v[136:137], v[136:137], s[36:37]
    v_pk_mul_f32 v[138:139], v[138:139], s[36:37]
    v_cvt_pk_bf16_f32 v132, v132, v133
    v_cvt_pk_bf16_f32 v134, v134, v135
    v_cvt_pk_bf16_f32 v136, v136, v137
    v_cvt_pk_bf16_f32 v138, v138, v139
    v_accvgpr_write_b32 a32, v132
    v_accvgpr_write_b32 a33, v134
    v_accvgpr_write_b32 a34, v136
    v_accvgpr_write_b32 a35, v138
    s_waitcnt lgkmcnt(2)
    v_lshlrev_b32 v132, 16, v112
    v_and_b32 v133, 0xffff0000, v112
    v_lshlrev_b32 v134, 16, v113
    v_and_b32 v135, 0xffff0000, v113
    v_lshlrev_b32 v136, 16, v114
    v_and_b32 v137, 0xffff0000, v114
    v_lshlrev_b32 v138, 16, v115
    v_and_b32 v139, 0xffff0000, v115
    v_pk_mul_f32 v[132:133], v[132:133], s[36:37]
    v_pk_mul_f32 v[134:135], v[134:135], s[36:37]
    v_pk_mul_f32 v[136:137], v[136:137], s[36:37]
    v_pk_mul_f32 v[138:139], v[138:139], s[36:37]
    v_cvt_pk_bf16_f32 v132, v132, v133
    v_cvt_pk_bf16_f32 v134, v134, v135
    v_cvt_pk_bf16_f32 v136, v136, v137
    v_cvt_pk_bf16_f32 v138, v138, v139
    v_accvgpr_write_b32 a36, v132
    v_accvgpr_write_b32 a37, v134
    v_accvgpr_write_b32 a38, v136
    v_accvgpr_write_b32 a39, v138
    buffer_load_dwordx4 v244, s[16:19], s31 offen offset:2048 nt lds
    s_waitcnt lgkmcnt(1)
    v_lshlrev_b32 v132, 16, v116
    v_and_b32 v133, 0xffff0000, v116
    v_lshlrev_b32 v134, 16, v117
    v_and_b32 v135, 0xffff0000, v117
    v_lshlrev_b32 v136, 16, v118
    v_and_b32 v137, 0xffff0000, v118
    v_lshlrev_b32 v138, 16, v119
    v_and_b32 v139, 0xffff0000, v119
    v_pk_mul_f32 v[132:133], v[132:133], s[36:37]
    v_pk_mul_f32 v[134:135], v[134:135], s[36:37]
    v_pk_mul_f32 v[136:137], v[136:137], s[36:37]
    v_pk_mul_f32 v[138:139], v[138:139], s[36:37]
    v_cvt_pk_bf16_f32 v132, v132, v133
    v_cvt_pk_bf16_f32 v134, v134, v135
    v_cvt_pk_bf16_f32 v136, v136, v137
    v_cvt_pk_bf16_f32 v138, v138, v139
    v_accvgpr_write_b32 a40, v132
    v_accvgpr_write_b32 a41, v134
    v_accvgpr_write_b32 a42, v136
    v_accvgpr_write_b32 a43, v138
    s_waitcnt lgkmcnt(0)
    v_lshlrev_b32 v132, 16, v120
    v_and_b32 v133, 0xffff0000, v120
    v_lshlrev_b32 v134, 16, v121
    v_and_b32 v135, 0xffff0000, v121
    v_lshlrev_b32 v136, 16, v122
    v_and_b32 v137, 0xffff0000, v122
    v_lshlrev_b32 v138, 16, v123
    v_and_b32 v139, 0xffff0000, v123
    v_pk_mul_f32 v[132:133], v[132:133], s[36:37]
    v_pk_mul_f32 v[134:135], v[134:135], s[36:37]
    v_pk_mul_f32 v[136:137], v[136:137], s[36:37]
    v_pk_mul_f32 v[138:139], v[138:139], s[36:37]
    v_cvt_pk_bf16_f32 v132, v132, v133
    v_cvt_pk_bf16_f32 v134, v134, v135
    v_cvt_pk_bf16_f32 v136, v136, v137
    v_cvt_pk_bf16_f32 v138, v138, v139
    v_accvgpr_write_b32 a44, v132
    v_accvgpr_write_b32 a45, v134
    v_accvgpr_write_b32 a46, v136
    v_accvgpr_write_b32 a47, v138
    v_mfma_f32_16x16x32_bf16 v[48:51], a[48:51], a[32:35], 0
    buffer_load_dwordx4 v244, s[16:19], s31 offen offset:3072 nt lds
    v_mfma_f32_16x16x32_bf16 v[48:51], a[52:55], a[36:39], v[48:51]
    v_mfma_f32_16x16x32_bf16 v[48:51], a[56:59], a[40:43], v[48:51]
    v_mfma_f32_16x16x32_bf16 v[48:51], a[60:63], a[44:47], v[48:51]
    v_mfma_f32_16x16x32_bf16 v[68:71], a[76:79], a[44:47], 0
    s_nop 2
    v_mfma_f32_16x16x32_bf16 v[68:71], a[72:75], a[40:43], v[68:71]
    s_nop 2
    v_mfma_f32_16x16x32_bf16 v[68:71], a[68:71], a[36:39], v[68:71]
    v_exp_f32 v48, v48
    v_mfma_f32_16x16x32_bf16 v[68:71], a[64:67], a[32:35], v[68:71]
    v_exp_f32 v49, v49
    v_mfma_f32_16x16x32_bf16 v[72:75], a[80:83], a[32:35], 0
    v_exp_f32 v50, v50
    v_mfma_f32_16x16x32_bf16 v[72:75], a[84:87], a[36:39], v[72:75]
    v_exp_f32 v51, v51
    v_cvt_pk_bf16_f32 v48, v48, v49
    v_mfma_f32_16x16x32_bf16 v[72:75], a[88:91], a[40:43], v[72:75]
    v_cvt_pk_bf16_f32 v50, v50, v51
    v_accvgpr_write_b32 a192, v48
    v_mfma_f32_16x16x32_bf16 v[72:75], a[92:95], a[44:47], v[72:75]
    s_add_u32 m0, s30, 65536
    v_accvgpr_write_b32 a193, v50
    v_exp_f32 v68, v68
    v_mfma_f32_16x16x32_bf16 v[92:95], a[108:111], a[44:47], 0
    s_add_u32 s31, s29, 65536
    v_exp_f32 v69, v69
    v_mfma_f32_16x16x32_bf16 v[92:95], a[104:107], a[40:43], v[92:95]
    v_exp_f32 v70, v70
    v_cvt_pk_bf16_f32 v68, v68, v69
    v_mfma_f32_16x16x32_bf16 v[92:95], a[100:103], a[36:39], v[92:95]
    v_exp_f32 v71, v71
    v_mfma_f32_16x16x32_bf16 v[92:95], a[96:99], a[32:35], v[92:95]
    v_cvt_pk_bf16_f32 v70, v70, v71
    v_accvgpr_write_b32 a194, v68
    v_accvgpr_write_b32 a195, v70
    v_mfma_f32_16x16x32_bf16 v[0:3], a[112:115], a[32:35], 0
    v_exp_f32 v72, v72
    v_mfma_f32_16x16x32_bf16 v[0:3], a[116:119], a[36:39], v[0:3]
    v_exp_f32 v73, v73
    v_mfma_f32_16x16x32_bf16 v[0:3], a[120:123], a[40:43], v[0:3]
    v_exp_f32 v74, v74
    v_mfma_f32_16x16x32_bf16 v[0:3], a[124:127], a[44:47], v[0:3]
    s_waitcnt vmcnt(3)
    v_exp_f32 v75, v75
    v_cvt_pk_bf16_f32 v72, v72, v73
    v_smfmac_f32_16x16x64_bf16 v[96:99], a[252:255], a[176:183], v246
    s_barrier
    v_smfmac_f32_16x16x64_bf16 v[100:103], a[252:255], a[184:191], v246
    buffer_load_dwordx4 v244, s[16:19], s31 offen offset:0 nt lds
    v_mfma_f32_16x16x32_bf16 v[20:23], a[140:143], a[44:47], 0
    ds_read_b128 a[48:51], v236 offset:32768
    ds_read_b128 a[52:55], v237 offset:32768
    v_mfma_f32_16x16x32_bf16 v[20:23], a[136:139], a[40:43], v[20:23]
    v_cvt_pk_bf16_f32 v74, v74, v75
    v_accvgpr_write_b32 a196, v72
    v_accvgpr_write_b32 a197, v74
    v_mfma_f32_16x16x32_bf16 v[20:23], a[132:135], a[36:39], v[20:23]
    v_exp_f32 v0, v0
    v_mfma_f32_16x16x32_bf16 v[20:23], a[128:131], a[32:35], v[20:23]
    ds_read_b128 a[56:59], v238 offset:32768
    ds_read_b128 a[60:63], v239 offset:32768
    v_mfma_f32_16x16x32_bf16 v[24:27], a[144:147], a[32:35], 0
    v_exp_f32 v1, v1
    v_mfma_f32_16x16x32_bf16 v[24:27], a[148:151], a[36:39], v[24:27]
    v_exp_f32 v92, v92
    v_cvt_pk_bf16_f32 v0, v0, v1
    v_mfma_f32_16x16x32_bf16 v[24:27], a[152:155], a[40:43], v[24:27]
    v_exp_f32 v2, v2
    v_mfma_f32_16x16x32_bf16 v[24:27], a[156:159], a[44:47], v[24:27]
    v_exp_f32 v93, v93
    v_accvgpr_write_b32 a216, v0
    v_mfma_f32_16x16x32_bf16 v[44:47], a[172:175], a[44:47], 0
    s_waitcnt vmcnt(3)
    ds_read_b128 a[64:67], v236 offset:33792
    ds_read_b128 a[68:71], v237 offset:33792
    v_mfma_f32_16x16x32_bf16 v[44:47], a[168:171], a[40:43], v[44:47]
    buffer_load_dwordx4 v244, s[16:19], s31 offen offset:1024 nt lds
    v_mfma_f32_16x16x32_bf16 v[44:47], a[164:167], a[36:39], v[44:47]
    v_exp_f32 v3, v3
    v_mfma_f32_16x16x32_bf16 v[44:47], a[160:163], a[32:35], v[44:47]
    s_waitcnt lgkmcnt(4)
    v_exp_f32 v94, v94
    v_cvt_pk_bf16_f32 v2, v2, v3
    v_mfma_f32_16x16x32_bf16 v[48:51], a[48:51], a[32:35], 0
    v_exp_f32 v95, v95
    v_mfma_f32_16x16x32_bf16 v[48:51], a[52:55], a[36:39], v[48:51]
    s_waitcnt lgkmcnt(2)
    v_accvgpr_write_b32 a217, v2
    v_cvt_pk_bf16_f32 v92, v92, v93
    v_cvt_pk_bf16_f32 v94, v94, v95
    v_mfma_f32_16x16x32_bf16 v[48:51], a[56:59], a[40:43], v[48:51]
    v_accvgpr_write_b32 a198, v92
    v_accvgpr_write_b32 a199, v94
    v_mfma_f32_16x16x32_bf16 v[48:51], a[60:63], a[44:47], v[48:51]
    s_waitcnt vmcnt(3)
    ds_read_b128 a[72:75], v238 offset:33792
    ds_read_b128 a[76:79], v239 offset:33792
    v_mfma_f32_16x16x32_bf16 v[52:55], a[60:63], a[28:31], 0
    buffer_load_dwordx4 v244, s[16:19], s31 offen offset:2048 nt lds
    v_mfma_f32_16x16x32_bf16 v[52:55], a[56:59], a[24:27], v[52:55]
    v_exp_f32 v20, v20
    v_mfma_f32_16x16x32_bf16 v[52:55], a[52:55], a[20:23], v[52:55]
    v_exp_f32 v21, v21
    v_mfma_f32_16x16x32_bf16 v[52:55], a[48:51], a[16:19], v[52:55]
    v_exp_f32 v22, v22
    v_cvt_pk_bf16_f32 v20, v20, v21
    v_mfma_f32_16x16x32_bf16 v[56:59], a[48:51], a[0:3], 0
    ds_read_b128 a[80:83], v236 offset:34816
    ds_read_b128 a[84:87], v237 offset:34816
    v_mfma_f32_16x16x32_bf16 v[56:59], a[52:55], a[4:7], v[56:59]
    v_exp_f32 v23, v23
    v_accvgpr_write_b32 a218, v20
    v_mfma_f32_16x16x32_bf16 v[56:59], a[56:59], a[8:11], v[56:59]
    v_cvt_pk_bf16_f32 v22, v22, v23
    v_accvgpr_write_b32 a219, v22
    v_mfma_f32_16x16x32_bf16 v[56:59], a[60:63], a[12:15], v[56:59]
    s_waitcnt lgkmcnt(2)
    v_exp_f32 v24, v24
    v_mfma_f32_16x16x32_bf16 v[60:63], a[76:79], a[12:15], 0
    v_exp_f32 v25, v25
    v_mfma_f32_16x16x32_bf16 v[60:63], a[72:75], a[8:11], v[60:63]
    v_exp_f32 v26, v26
    v_cvt_pk_bf16_f32 v24, v24, v25
    v_mfma_f32_16x16x32_bf16 v[60:63], a[68:71], a[4:7], v[60:63]
    v_exp_f32 v27, v27
    v_mfma_f32_16x16x32_bf16 v[60:63], a[64:67], a[0:3], v[60:63]
    s_waitcnt vmcnt(4)
    ds_read_b128 a[88:91], v238 offset:34816
    ds_read_b128 a[92:95], v239 offset:34816
    v_cvt_pk_bf16_f32 v26, v26, v27
    v_mfma_f32_16x16x32_bf16 v[64:67], a[64:67], a[16:19], 0
    buffer_load_dwordx4 v244, s[16:19], s31 offen offset:3072 nt lds
    v_mfma_f32_16x16x32_bf16 v[64:67], a[68:71], a[20:23], v[64:67]
    s_add_u32 m0, s30, 81920
    v_accvgpr_write_b32 a220, v24
    v_accvgpr_write_b32 a221, v26
    v_mfma_f32_16x16x32_bf16 v[64:67], a[72:75], a[24:27], v[64:67]
    s_add_u32 s31, s29, 81920
    v_exp_f32 v48, v48
    v_mfma_f32_16x16x32_bf16 v[64:67], a[76:79], a[28:31], v[64:67]
    v_exp_f32 v49, v49
    v_mfma_f32_16x16x32_bf16 v[68:71], a[76:79], a[44:47], 0
    s_waitcnt vmcnt(4)
    ds_read_b128 a[96:99], v236 offset:35840
    ds_read_b128 a[100:103], v237 offset:35840
    v_mfma_f32_16x16x32_bf16 v[68:71], a[72:75], a[40:43], v[68:71]
    buffer_load_dwordx4 v244, s[16:19], s31 offen offset:0 nt lds
    v_mfma_f32_16x16x32_bf16 v[68:71], a[68:71], a[36:39], v[68:71]
    v_exp_f32 v50, v50
    v_mfma_f32_16x16x32_bf16 v[68:71], a[64:67], a[32:35], v[68:71]
    s_waitcnt lgkmcnt(2)
    v_exp_f32 v51, v51
    v_cvt_pk_bf16_f32 v48, v48, v49
    v_mfma_f32_16x16x32_bf16 v[72:75], a[80:83], a[32:35], 0
    v_exp_f32 v52, v52
    v_mfma_f32_16x16x32_bf16 v[72:75], a[84:87], a[36:39], v[72:75]
    v_cvt_pk_bf16_f32 v50, v50, v51
    v_exp_f32 v53, v53
    v_mfma_f32_16x16x32_bf16 v[72:75], a[88:91], a[40:43], v[72:75]
    v_accvgpr_write_b32 a240, v48
    v_accvgpr_write_b32 a241, v50
    v_mfma_f32_16x16x32_bf16 v[72:75], a[92:95], a[44:47], v[72:75]
    s_waitcnt vmcnt(4)
    ds_read_b128 a[104:107], v238 offset:35840
    ds_read_b128 a[108:111], v239 offset:35840
    v_cvt_pk_bf16_f32 v52, v52, v53
    v_mfma_f32_16x16x32_bf16 v[76:79], a[92:95], a[28:31], 0
    buffer_load_dwordx4 v244, s[16:19], s31 offen offset:1024 nt lds
    v_mfma_f32_16x16x32_bf16 v[76:79], a[88:91], a[24:27], v[76:79]
    v_exp_f32 v54, v54
    v_accvgpr_write_b32 a232, v52
    v_mfma_f32_16x16x32_bf16 v[76:79], a[84:87], a[20:23], v[76:79]
    v_exp_f32 v55, v55
    v_mfma_f32_16x16x32_bf16 v[76:79], a[80:83], a[16:19], v[76:79]
    v_exp_f32 v56, v56
    v_cvt_pk_bf16_f32 v54, v54, v55
    v_mfma_f32_16x16x32_bf16 v[80:83], a[80:83], a[0:3], 0
    v_exp_f32 v57, v57
    v_mfma_f32_16x16x32_bf16 v[80:83], a[84:87], a[4:7], v[80:83]
    s_waitcnt lgkmcnt(0)
    v_accvgpr_write_b32 a233, v54
    v_exp_f32 v58, v58
    v_mfma_f32_16x16x32_bf16 v[80:83], a[88:91], a[8:11], v[80:83]
    s_waitcnt vmcnt(6)
    v_exp_f32 v44, v44
    v_mfma_f32_16x16x32_bf16 v[80:83], a[92:95], a[12:15], v[80:83]
    s_barrier
    v_smfmac_f32_16x16x64_bf16 v[104:107], a[252:255], a[192:199], v246
    v_cvt_pk_bf16_f32 v56, v56, v57
    v_mfma_f32_16x16x32_bf16 v[84:87], a[108:111], a[12:15], 0
    s_waitcnt vmcnt(4)
    ds_read_b128 a[48:51], v236 offset:49152
    ds_read_b128 a[52:55], v237 offset:49152
    v_accvgpr_write_b32 a224, v56
    v_mfma_f32_16x16x32_bf16 v[84:87], a[104:107], a[8:11], v[84:87]
    buffer_load_dwordx4 v244, s[16:19], s31 offen offset:2048 nt lds
    v_mfma_f32_16x16x32_bf16 v[84:87], a[100:103], a[4:7], v[84:87]
    v_exp_f32 v59, v59
    v_mfma_f32_16x16x32_bf16 v[84:87], a[96:99], a[0:3], v[84:87]
    ds_read_b128 a[56:59], v238 offset:49152
    ds_read_b128 a[60:63], v239 offset:49152
    v_mfma_f32_16x16x32_bf16 v[88:91], a[96:99], a[16:19], 0
    v_exp_f32 v45, v45
    v_cvt_pk_bf16_f32 v58, v58, v59
    v_mfma_f32_16x16x32_bf16 v[88:91], a[100:103], a[20:23], v[88:91]
    v_exp_f32 v46, v46
    v_mfma_f32_16x16x32_bf16 v[88:91], a[104:107], a[24:27], v[88:91]
    v_accvgpr_write_b32 a225, v58
    v_exp_f32 v47, v47
    v_mfma_f32_16x16x32_bf16 v[88:91], a[108:111], a[28:31], v[88:91]
    v_cvt_pk_bf16_f32 v44, v44, v45
    v_cvt_pk_bf16_f32 v46, v46, v47
    v_mfma_f32_16x16x32_bf16 v[92:95], a[108:111], a[44:47], 0
    s_waitcnt vmcnt(4)
    ds_read_b128 a[64:67], v236 offset:50176
    ds_read_b128 a[68:71], v237 offset:50176
    v_accvgpr_write_b32 a222, v44
    v_mfma_f32_16x16x32_bf16 v[92:95], a[104:107], a[40:43], v[92:95]
    buffer_load_dwordx4 v244, s[16:19], s31 offen offset:3072 nt lds
    v_mfma_f32_16x16x32_bf16 v[92:95], a[100:103], a[36:39], v[92:95]
    s_add_u32 m0, s30, 98304
    v_accvgpr_write_b32 a223, v46
    v_exp_f32 v60, v60
    v_mfma_f32_16x16x32_bf16 v[92:95], a[96:99], a[32:35], v[92:95]
    s_waitcnt lgkmcnt(4)
    v_exp_f32 v61, v61
    v_mfma_f32_16x16x32_bf16 v[0:3], a[48:51], a[32:35], 0
    s_add_u32 s31, s29, 98304
    v_exp_f32 v62, v62
    v_cvt_pk_bf16_f32 v60, v60, v61
    v_mfma_f32_16x16x32_bf16 v[0:3], a[52:55], a[36:39], v[0:3]
    s_waitcnt lgkmcnt(2)
    v_exp_f32 v63, v63
    v_accvgpr_write_b32 a226, v60
    v_mfma_f32_16x16x32_bf16 v[0:3], a[56:59], a[40:43], v[0:3]
    v_cvt_pk_bf16_f32 v62, v62, v63
    v_exp_f32 v64, v64
    v_mfma_f32_16x16x32_bf16 v[0:3], a[60:63], a[44:47], v[0:3]
    ds_read_b128 a[72:75], v238 offset:50176
    ds_read_b128 a[76:79], v239 offset:50176
    v_accvgpr_write_b32 a227, v62
    v_mfma_f32_16x16x32_bf16 v[4:7], a[60:63], a[28:31], 0
    v_exp_f32 v65, v65
    v_mfma_f32_16x16x32_bf16 v[4:7], a[56:59], a[24:27], v[4:7]
    v_exp_f32 v66, v66
    v_cvt_pk_bf16_f32 v64, v64, v65
    v_mfma_f32_16x16x32_bf16 v[4:7], a[52:55], a[20:23], v[4:7]
    v_exp_f32 v67, v67
    v_accvgpr_write_b32 a234, v64
    v_mfma_f32_16x16x32_bf16 v[4:7], a[48:51], a[16:19], v[4:7]
    v_cvt_pk_bf16_f32 v66, v66, v67
    v_exp_f32 v68, v68
    v_mfma_f32_16x16x32_bf16 v[8:11], a[48:51], a[0:3], 0
    s_waitcnt vmcnt(4)
    ds_read_b128 a[80:83], v236 offset:51200
    ds_read_b128 a[84:87], v237 offset:51200
    v_accvgpr_write_b32 a235, v66
    v_mfma_f32_16x16x32_bf16 v[8:11], a[52:55], a[4:7], v[8:11]
    buffer_load_dwordx4 v244, s[16:19], s31 offen offset:0 nt lds
    v_mfma_f32_16x16x32_bf16 v[8:11], a[56:59], a[8:11], v[8:11]
    v_exp_f32 v69, v69
    v_mfma_f32_16x16x32_bf16 v[8:11], a[60:63], a[12:15], v[8:11]
    s_waitcnt lgkmcnt(2)
    v_exp_f32 v70, v70
    v_cvt_pk_bf16_f32 v68, v68, v69
    v_mfma_f32_16x16x32_bf16 v[12:15], a[76:79], a[12:15], 0
    v_exp_f32 v71, v71
    v_accvgpr_write_b32 a242, v68
    v_mfma_f32_16x16x32_bf16 v[12:15], a[72:75], a[8:11], v[12:15]
    v_cvt_pk_bf16_f32 v70, v70, v71
    v_accvgpr_write_b32 a243, v70
    v_mfma_f32_16x16x32_bf16 v[12:15], a[68:71], a[4:7], v[12:15]
    v_exp_f32 v72, v72
    v_mfma_f32_16x16x32_bf16 v[12:15], a[64:67], a[0:3], v[12:15]
    s_waitcnt vmcnt(4)
    ds_read_b128 a[88:91], v238 offset:51200
    ds_read_b128 a[92:95], v239 offset:51200
    v_mfma_f32_16x16x32_bf16 v[16:19], a[64:67], a[16:19], 0
    buffer_load_dwordx4 v244, s[16:19], s31 offen offset:1024 nt lds
    v_mfma_f32_16x16x32_bf16 v[16:19], a[68:71], a[20:23], v[16:19]
L_stub0:
    s_cbranch_scc1 L_ret
    v_exp_f32 v73, v73
    v_mfma_f32_16x16x32_bf16 v[16:19], a[72:75], a[24:27], v[16:19]
    v_exp_f32 v74, v74
    v_cvt_pk_bf16_f32 v72, v72, v73
    v_mfma_f32_16x16x32_bf16 v[16:19], a[76:79], a[28:31], v[16:19]
    v_exp_f32 v75, v75
    v_accvgpr_write_b32 a244, v72
    v_mfma_f32_16x16x32_bf16 v[20:23], a[76:79], a[44:47], 0
    ds_read_b128 a[96:99], v236 offset:52224
    ds_read_b128 a[100:103], v237 offset:52224
    v_cvt_pk_bf16_f32 v74, v74, v75
    v_mfma_f32_16x16x32_bf16 v[20:23], a[72:75], a[40:43], v[20:23]
    v_exp_f32 v76, v76
    v_accvgpr_write_b32 a245, v74
    v_mfma_f32_16x16x32_bf16 v[20:23], a[68:71], a[36:39], v[20:23]
    v_exp_f32 v77, v77
    v_mfma_f32_16x16x32_bf16 v[20:23], a[64:67], a[32:35], v[20:23]
    s_waitcnt lgkmcnt(2)
    v_exp_f32 v78, v78
    v_cvt_pk_bf16_f32 v76, v76, v77
    v_mfma_f32_16x16x32_bf16 v[24:27], a[80:83], a[32:35], 0
    v_exp_f32 v79, v79
    v_accvgpr_write_b32 a236, v76
    v_mfma_f32_16x16x32_bf16 v[24:27], a[84:87], a[36:39], v[24:27]
    v_exp_f32 v80, v80
    v_cvt_pk_bf16_f32 v78, v78, v79
    v_mfma_f32_16x16x32_bf16 v[24:27], a[88:91], a[40:43], v[24:27]
    v_exp_f32 v81, v81
    v_accvgpr_write_b32 a237, v78
    v_mfma_f32_16x16x32_bf16 v[24:27], a[92:95], a[44:47], v[24:27]
    s_waitcnt vmcnt(4)
    ds_read_b128 a[104:107], v238 offset:52224
    ds_read_b128 a[108:111], v239 offset:52224
    v_cvt_pk_bf16_f32 v80, v80, v81
    v_mfma_f32_16x16x32_bf16 v[28:31], a[92:95], a[28:31], 0
    buffer_load_dwordx4 v244, s[16:19], s31 offen offset:2048 nt lds
    v_mfma_f32_16x16x32_bf16 v[28:31], a[88:91], a[24:27], v[28:31]
    v_exp_f32 v82, v82
    v_accvgpr_write_b32 a228, v80
    v_mfma_f32_16x16x32_bf16 v[28:31], a[84:87], a[20:23], v[28:31]
    v_exp_f32 v83, v83
    v_mfma_f32_16x16x32_bf16 v[28:31], a[80:83], a[16:19], v[28:31]
    v_cvt_pk_bf16_f32 v82, v82, v83
    v_accvgpr_write_b32 a229, v82
    v_mfma_f32_16x16x32_bf16 v[32:35], a[80:83], a[0:3], 0
    v_exp_f32 v0, v0
    v_mfma_f32_16x16x32_bf16 v[32:35], a[84:87], a[4:7], v[32:35]
    v_exp_f32 v84, v84
    v_mfma_f32_16x16x32_bf16 v[32:35], a[88:91], a[8:11], v[32:35]
    s_waitcnt lgkmcnt(0)
    v_exp_f32 v1, v1
    v_mfma_f32_16x16x32_bf16 v[32:35], a[92:95], a[12:15], v[32:35]
    s_waitcnt vmcnt(4)
    v_exp_f32 v85, v85
    v_cvt_pk_bf16_f32 v124, v0, v1
    v_smfmac_f32_16x16x64_bf16 v[96:99], a[252:255], a[200:207], v246
    s_barrier
    v_smfmac_f32_16x16x64_bf16 v[100:103], a[252:255], a[208:215], v246
    buffer_load_dwordx4 v244, s[16:19], s31 offen offset:3072 nt lds
    v_mfma_f32_16x16x32_bf16 v[36:39], a[108:111], a[12:15], 0
    s_add_u32 m0, s30, 114688
    ds_read_b128 a[48:51], v240 offset:0
    ds_read_b128 a[52:55], v241 offset:0
    v_cvt_pk_bf16_f32 v84, v84, v85
    v_mfma_f32_16x16x32_bf16 v[36:39], a[104:107], a[8:11], v[36:39]
    s_add_u32 s31, s29, 114688
    v_exp_f32 v2, v2
    v_accvgpr_write_b32 a230, v84
    v_mfma_f32_16x16x32_bf16 v[36:39], a[100:103], a[4:7], v[36:39]
    v_exp_f32 v86, v86
    v_mfma_f32_16x16x32_bf16 v[36:39], a[96:99], a[0:3], v[36:39]
    ds_read_b128 a[56:59], v242 offset:0
    ds_read_b128 a[60:63], v243 offset:0
    v_mfma_f32_16x16x32_bf16 v[40:43], a[96:99], a[16:19], 0
    v_exp_f32 v3, v3
    v_mfma_f32_16x16x32_bf16 v[40:43], a[100:103], a[20:23], v[40:43]
    v_exp_f32 v87, v87
    v_cvt_pk_bf16_f32 v125, v2, v3
    v_mfma_f32_16x16x32_bf16 v[40:43], a[104:107], a[24:27], v[40:43]
    v_exp_f32 v4, v4
    v_cvt_pk_bf16_f32 v86, v86, v87
    v_mfma_f32_16x16x32_bf16 v[40:43], a[108:111], a[28:31], v[40:43]
    v_exp_f32 v88, v88
    v_accvgpr_write_b32 a231, v86
    v_mfma_f32_16x16x32_bf16 v[44:47], a[108:111], a[44:47], 0
    s_waitcnt vmcnt(4)
    v_exp_f32 v5, v5
    v_mfma_f32_16x16x32_bf16 v[44:47], a[104:107], a[40:43], v[44:47]
    buffer_load_dwordx4 v244, s[16:19], s31 offen offset:0 nt lds
    v_mfma_f32_16x16x32_bf16 v[44:47], a[100:103], a[36:39], v[44:47]
    v_exp_f32 v89, v89
    v_cvt_pk_bf16_f32 v116, v4, v5
    v_mfma_f32_16x16x32_bf16 v[44:47], a[96:99], a[32:35], v[44:47]
    s_waitcnt lgkmcnt(2)
    v_exp_f32 v6, v6
    v_cvt_pk_bf16_f32 v88, v88, v89
    v_mfma_f32_16x16x32_bf16 v[48:51], a[48:51], a[32:35], 0
    v_exp_f32 v90, v90
    v_accvgpr_write_b32 a238, v88
    v_mfma_f32_16x16x32_bf16 v[48:51], a[52:55], a[36:39], v[48:51]
    s_waitcnt lgkmcnt(0)
    v_exp_f32 v7, v7
    v_mfma_f32_16x16x32_bf16 v[48:51], a[56:59], a[40:43], v[48:51]
    v_exp_f32 v91, v91
    v_cvt_pk_bf16_f32 v117, v6, v7
    v_mfma_f32_16x16x32_bf16 v[48:51], a[60:63], a[44:47], v[48:51]
    s_waitcnt vmcnt(4)
    v_exp_f32 v8, v8
    v_cvt_pk_bf16_f32 v90, v90, v91
    v_mfma_f32_16x16x32_bf16 v[52:55], a[60:63], a[28:31], 0
    buffer_load_dwordx4 v244, s[16:19], s31 offen offset:1024 nt lds
    v_mfma_f32_16x16x32_bf16 v[52:55], a[56:59], a[24:27], v[52:55]
    v_exp_f32 v92, v92
    v_accvgpr_write_b32 a239, v90
    v_mfma_f32_16x16x32_bf16 v[52:55], a[52:55], a[20:23], v[52:55]
    v_exp_f32 v9, v9
    v_mfma_f32_16x16x32_bf16 v[52:55], a[48:51], a[16:19], v[52:55]
    v_exp_f32 v93, v93
    v_cvt_pk_bf16_f32 v108, v8, v9
    v_mfma_f32_16x16x32_bf16 v[56:59], a[48:51], a[0:3], 0
    ds_read_b128 a[64:67], v240 offset:1024
    ds_read_b128 a[68:71], v241 offset:1024
    v_cvt_pk_bf16_f32 v92, v92, v93
    v_mfma_f32_16x16x32_bf16 v[56:59], a[52:55], a[4:7], v[56:59]
    ds_read_b128 a[72:75], v242 offset:1024
    ds_read_b128 a[76:79], v243 offset:1024
    v_accvgpr_write_b32 a246, v92
    v_mfma_f32_16x16x32_bf16 v[56:59], a[56:59], a[8:11], v[56:59]
    v_exp_f32 v10, v10
    v_mfma_f32_16x16x32_bf16 v[56:59], a[60:63], a[12:15], v[56:59]
    s_waitcnt lgkmcnt(0)
    v_exp_f32 v94, v94
    v_mfma_f32_16x16x32_bf16 v[60:63], a[76:79], a[12:15], 0
    v_exp_f32 v11, v11
    v_mfma_f32_16x16x32_bf16 v[60:63], a[72:75], a[8:11], v[60:63]
    v_exp_f32 v95, v95
    v_cvt_pk_bf16_f32 v109, v10, v11
    v_mfma_f32_16x16x32_bf16 v[60:63], a[68:71], a[4:7], v[60:63]
    v_cvt_pk_bf16_f32 v94, v94, v95
    v_accvgpr_write_b32 a247, v94
    v_mfma_f32_16x16x32_bf16 v[60:63], a[64:67], a[0:3], v[60:63]
    s_waitcnt vmcnt(4)
    v_exp_f32 v12, v12
    v_mfma_f32_16x16x32_bf16 v[64:67], a[64:67], a[16:19], 0
    buffer_load_dwordx4 v244, s[16:19], s31 offen offset:2048 nt lds
    v_mfma_f32_16x16x32_bf16 v[64:67], a[68:71], a[20:23], v[64:67]
    v_exp_f32 v13, v13
    v_mfma_f32_16x16x32_bf16 v[64:67], a[72:75], a[24:27], v[64:67]
    v_exp_f32 v14, v14
    v_cvt_pk_bf16_f32 v110, v12, v13
    v_mfma_f32_16x16x32_bf16 v[64:67], a[76:79], a[28:31], v[64:67]
    v_exp_f32 v15, v15
    v_mfma_f32_16x16x32_bf16 v[68:71], a[76:79], a[44:47], 0
    v_exp_f32 v16, v16
    v_cvt_pk_bf16_f32 v111, v14, v15
    v_mfma_f32_16x16x32_bf16 v[68:71], a[72:75], a[40:43], v[68:71]
    v_exp_f32 v17, v17
    v_mfma_f32_16x16x32_bf16 v[68:71], a[68:71], a[36:39], v[68:71]
    s_waitcnt vmcnt(7)
    ds_read_b128 a[80:83], v240 offset:2048
    ds_read_b128 a[84:87], v241 offset:2048
    v_cvt_pk_bf16_f32 v118, v16, v17
    v_mfma_f32_16x16x32_bf16 v[68:71], a[64:67], a[32:35], v[68:71]
    ds_read_b128 a[88:91], v242 offset:2048
    ds_read_b128 a[92:95], v243 offset:2048
    s_waitcnt lgkmcnt(0)
    v_mfma_f32_16x16x32_bf16 v[72:75], a[80:83], a[32:35], 0
    buffer_load_dwordx4 v244, s[16:19], s31 offen offset:3072 nt lds
    v_mfma_f32_16x16x32_bf16 v[72:75], a[84:87], a[36:39], v[72:75]
    s_add_u32 m0, s30, 0
    v_exp_f32 v18, v18
    v_mfma_f32_16x16x32_bf16 v[72:75], a[88:91], a[40:43], v[72:75]
    s_add_u32 s31, s32, 0
    ds_read_b128 a[96:99], v240 offset:3072
    ds_read_b128 a[100:103], v241 offset:3072
    v_mfma_f32_16x16x32_bf16 v[72:75], a[92:95], a[44:47], v[72:75]
    v_exp_f32 v19, v19
    v_mfma_f32_16x16x32_bf16 v[76:79], a[92:95], a[28:31], 0
    v_exp_f32 v20, v20
    v_cvt_pk_bf16_f32 v119, v18, v19
    v_mfma_f32_16x16x32_bf16 v[76:79], a[88:91], a[24:27], v[76:79]
    ds_read_b128 a[104:107], v242 offset:3072
    ds_read_b128 a[108:111], v243 offset:3072
    v_mfma_f32_16x16x32_bf16 v[76:79], a[84:87], a[20:23], v[76:79]
    v_exp_f32 v21, v21
    v_mfma_f32_16x16x32_bf16 v[76:79], a[80:83], a[16:19], v[76:79]
    v_exp_f32 v22, v22
    v_cvt_pk_bf16_f32 v126, v20, v21
    v_mfma_f32_16x16x32_bf16 v[80:83], a[80:83], a[0:3], 0
    v_exp_f32 v23, v23
    v_mfma_f32_16x16x32_bf16 v[80:83], a[84:87], a[4:7], v[80:83]
    v_cvt_pk_bf16_f32 v127, v22, v23
    v_exp_f32 v24, v24
    v_mfma_f32_16x16x32_bf16 v[80:83], a[88:91], a[8:11], v[80:83]
    v_exp_f32 v25, v25
    v_mfma_f32_16x16x32_bf16 v[80:83], a[92:95], a[12:15], v[80:83]
    s_waitcnt lgkmcnt(0)
    v_exp_f32 v26, v26
    v_cvt_pk_bf16_f32 v128, v24, v25
    v_mfma_f32_16x16x32_bf16 v[84:87], a[108:111], a[12:15], 0
    s_waitcnt vmcnt(7)
    v_exp_f32 v27, v27
    v_mfma_f32_16x16x32_bf16 v[84:87], a[104:107], a[8:11], v[84:87]
    buffer_load_dwordx4 v245, s[20:23], s31 offen offset:0 nt lds
    v_mfma_f32_16x16x32_bf16 v[84:87], a[100:103], a[4:7], v[84:87]
    v_exp_f32 v28, v28
    v_cvt_pk_bf16_f32 v129, v26, v27
    v_mfma_f32_16x16x32_bf16 v[84:87], a[96:99], a[0:3], v[84:87]
    v_exp_f32 v29, v29
    v_mfma_f32_16x16x32_bf16 v[88:91], a[96:99], a[16:19], 0
    v_exp_f32 v30, v30
    v_cvt_pk_bf16_f32 v120, v28, v29
    v_mfma_f32_16x16x32_bf16 v[88:91], a[100:103], a[20:23], v[88:91]
    v_exp_f32 v31, v31
    v_mfma_f32_16x16x32_bf16 v[88:91], a[104:107], a[24:27], v[88:91]
    v_exp_f32 v32, v32
    v_cvt_pk_bf16_f32 v121, v30, v31
    v_mfma_f32_16x16x32_bf16 v[88:91], a[108:111], a[28:31], v[88:91]
    v_exp_f32 v33, v33
    v_mfma_f32_16x16x32_bf16 v[92:95], a[108:111], a[44:47], 0
    v_exp_f32 v34, v34
    v_cvt_pk_bf16_f32 v112, v32, v33
    v_mfma_f32_16x16x32_bf16 v[92:95], a[104:107], a[40:43], v[92:95]
    v_exp_f32 v35, v35
    v_mfma_f32_16x16x32_bf16 v[92:95], a[100:103], a[36:39], v[92:95]
    v_cvt_pk_bf16_f32 v113, v34, v35
    v_exp_f32 v36, v36
    v_mfma_f32_16x16x32_bf16 v[92:95], a[96:99], a[32:35], v[92:95]
    s_waitcnt vmcnt(9)
    v_exp_f32 v37, v37
    v_smfmac_f32_16x16x64_bf16 v[104:107], a[252:255], a[216:223], v246
    s_barrier
    ds_read_b128 a[48:51], v240 offset:16384
    ds_read_b128 a[52:55], v241 offset:16384
    v_smfmac_f32_16x16x64_bf16 v[96:99], a[252:255], a[224:231], v246
    s_waitcnt vmcnt(7)
    ds_read_b128 a[56:59], v242 offset:16384
    ds_read_b128 a[60:63], v243 offset:16384
    s_waitcnt lgkmcnt(0)
    v_mfma_f32_16x16x32_bf16 v[0:3], a[48:51], a[32:35], 0
    buffer_load_dwordx4 v245, s[20:23], s31 offen offset:1024 nt lds
    v_mfma_f32_16x16x32_bf16 v[0:3], a[52:55], a[36:39], v[0:3]
    v_exp_f32 v38, v38
    v_cvt_pk_bf16_f32 v114, v36, v37
    v_mfma_f32_16x16x32_bf16 v[0:3], a[56:59], a[40:43], v[0:3]
    v_exp_f32 v39, v39
    v_mfma_f32_16x16x32_bf16 v[0:3], a[60:63], a[44:47], v[0:3]
    s_waitcnt vmcnt(7)
    v_exp_f32 v40, v40
    v_cvt_pk_bf16_f32 v115, v38, v39
    v_mfma_f32_16x16x32_bf16 v[4:7], a[60:63], a[28:31], 0
    buffer_load_dwordx4 v245, s[20:23], s31 offen offset:2048 nt lds
    v_mfma_f32_16x16x32_bf16 v[4:7], a[56:59], a[24:27], v[4:7]
    v_exp_f32 v41, v41
    v_mfma_f32_16x16x32_bf16 v[4:7], a[52:55], a[20:23], v[4:7]
    v_exp_f32 v42, v42
    v_cvt_pk_bf16_f32 v122, v40, v41
    v_mfma_f32_16x16x32_bf16 v[4:7], a[48:51], a[16:19], v[4:7]
    v_exp_f32 v43, v43
    v_mfma_f32_16x16x32_bf16 v[8:11], a[48:51], a[0:3], 0
    v_exp_f32 v44, v44
    v_cvt_pk_bf16_f32 v123, v42, v43
    v_mfma_f32_16x16x32_bf16 v[8:11], a[52:55], a[4:7], v[8:11]
    v_exp_f32 v45, v45
    v_mfma_f32_16x16x32_bf16 v[8:11], a[56:59], a[8:11], v[8:11]
    v_exp_f32 v46, v46
    v_cvt_pk_bf16_f32 v130, v44, v45
    v_mfma_f32_16x16x32_bf16 v[8:11], a[60:63], a[12:15], v[8:11]
    ds_read_b128 a[76:79], v243 offset:17408
    ds_read_b128 a[72:75], v242 offset:17408
    s_waitcnt lgkmcnt(0)
    v_mfma_f32_16x16x32_bf16 v[12:15], a[76:79], a[12:15], 0
    s_waitcnt vmcnt(7)
    v_exp_f32 v47, v47
    v_mfma_f32_16x16x32_bf16 v[12:15], a[72:75], a[8:11], v[12:15]
    ds_read_b128 a[68:71], v241 offset:17408
    ds_read_b128 a[64:67], v240 offset:17408
    v_cvt_pk_bf16_f32 v131, v46, v47
    s_waitcnt lgkmcnt(0)
    v_mfma_f32_16x16x32_bf16 v[12:15], a[68:71], a[4:7], v[12:15]
    buffer_load_dwordx4 v245, s[20:23], s31 offen offset:3072 nt lds
    v_mfma_f32_16x16x32_bf16 v[12:15], a[64:67], a[0:3], v[12:15]
    s_add_u32 m0, s30, 16384
    v_exp_f32 v48, v48
    v_mfma_f32_16x16x32_bf16 v[16:19], a[64:67], a[16:19], 0
    s_add_u32 s31, s32, 32768
    v_exp_f32 v49, v49
    v_mfma_f32_16x16x32_bf16 v[16:19], a[68:71], a[20:23], v[16:19]
    v_exp_f32 v50, v50
    v_cvt_pk_bf16_f32 v148, v48, v49
    v_mfma_f32_16x16x32_bf16 v[16:19], a[72:75], a[24:27], v[16:19]
    v_exp_f32 v51, v51
    v_mfma_f32_16x16x32_bf16 v[16:19], a[76:79], a[28:31], v[16:19]
    v_exp_f32 v52, v52
    v_cvt_pk_bf16_f32 v149, v50, v51
    v_mfma_f32_16x16x32_bf16 v[20:23], a[76:79], a[44:47], 0
    v_exp_f32 v53, v53
    v_mfma_f32_16x16x32_bf16 v[20:23], a[72:75], a[40:43], v[20:23]
    v_exp_f32 v54, v54
    v_cvt_pk_bf16_f32 v140, v52, v53
    v_mfma_f32_16x16x32_bf16 v[20:23], a[68:71], a[36:39], v[20:23]
    s_waitcnt vmcnt(7)
    ds_read_b128 a[80:83], v240 offset:18432
    ds_read_b128 a[84:87], v241 offset:18432
    v_mfma_f32_16x16x32_bf16 v[20:23], a[64:67], a[32:35], v[20:23]
    ds_read_b128 a[88:91], v242 offset:18432
    ds_read_b128 a[92:95], v243 offset:18432
    s_waitcnt lgkmcnt(0)
    v_mfma_f32_16x16x32_bf16 v[24:27], a[80:83], a[32:35], 0
    buffer_load_dwordx4 v245, s[20:23], s31 offen offset:0 nt lds
    v_mfma_f32_16x16x32_bf16 v[24:27], a[84:87], a[36:39], v[24:27]
    v_exp_f32 v55, v55
    v_mfma_f32_16x16x32_bf16 v[24:27], a[88:91], a[40:43], v[24:27]
    ds_read_b128 a[96:99], v240 offset:19456
    ds_read_b128 a[100:103], v241 offset:19456
    v_cvt_pk_bf16_f32 v141, v54, v55
    v_mfma_f32_16x16x32_bf16 v[24:27], a[92:95], a[44:47], v[24:27]
    v_exp_f32 v56, v56
    v_mfma_f32_16x16x32_bf16 v[28:31], a[92:95], a[28:31], 0
    v_exp_f32 v57, v57
    v_mfma_f32_16x16x32_bf16 v[28:31], a[88:91], a[24:27], v[28:31]
    ds_read_b128 a[104:107], v242 offset:19456
    ds_read_b128 a[108:111], v243 offset:19456
    v_cvt_pk_bf16_f32 v132, v56, v57
    v_mfma_f32_16x16x32_bf16 v[28:31], a[84:87], a[20:23], v[28:31]
    v_exp_f32 v58, v58
    v_mfma_f32_16x16x32_bf16 v[28:31], a[80:83], a[16:19], v[28:31]
    v_exp_f32 v59, v59
    v_mfma_f32_16x16x32_bf16 v[32:35], a[80:83], a[0:3], 0
    v_cvt_pk_bf16_f32 v133, v58, v59
    v_exp_f32 v60, v60
    v_mfma_f32_16x16x32_bf16 v[32:35], a[84:87], a[4:7], v[32:35]
    v_exp_f32 v61, v61
    v_mfma_f32_16x16x32_bf16 v[32:35], a[88:91], a[8:11], v[32:35]
    v_exp_f32 v62, v62
    v_cvt_pk_bf16_f32 v134, v60, v61
    v_mfma_f32_16x16x32_bf16 v[32:35], a[92:95], a[12:15], v[32:35]
    s_waitcnt lgkmcnt(0)
    v_exp_f32 v63, v63
    v_mfma_f32_16x16x32_bf16 v[36:39], a[108:111], a[12:15], 0
    s_waitcnt vmcnt(7)
    v_exp_f32 v64, v64
    v_cvt_pk_bf16_f32 v135, v62, v63
    v_mfma_f32_16x16x32_bf16 v[36:39], a[104:107], a[8:11], v[36:39]
    buffer_load_dwordx4 v245, s[20:23], s31 offen offset:1024 nt lds
    v_mfma_f32_16x16x32_bf16 v[36:39], a[100:103], a[4:7], v[36:39]
    v_exp_f32 v65, v65
    v_mfma_f32_16x16x32_bf16 v[36:39], a[96:99], a[0:3], v[36:39]
    v_exp_f32 v66, v66
    v_cvt_pk_bf16_f32 v142, v64, v65
    v_mfma_f32_16x16x32_bf16 v[40:43], a[96:99], a[16:19], 0
    v_exp_f32 v67, v67
    v_mfma_f32_16x16x32_bf16 v[40:43], a[100:103], a[20:23], v[40:43]
    v_exp_f32 v68, v68
    v_cvt_pk_bf16_f32 v143, v66, v67
    v_mfma_f32_16x16x32_bf16 v[40:43], a[104:107], a[24:27], v[40:43]
    v_exp_f32 v69, v69
    v_mfma_f32_16x16x32_bf16 v[40:43], a[108:111], a[28:31], v[40:43]
    v_exp_f32 v70, v70
    v_cvt_pk_bf16_f32 v150, v68, v69
    v_mfma_f32_16x16x32_bf16 v[44:47], a[108:111], a[44:47], 0
    v_exp_f32 v71, v71
    v_mfma_f32_16x16x32_bf16 v[44:47], a[104:107], a[40:43], v[44:47]
    v_cvt_pk_bf16_f32 v151, v70, v71
    v_exp_f32 v72, v72
    v_mfma_f32_16x16x32_bf16 v[44:47], a[100:103], a[36:39], v[44:47]
    v_exp_f32 v73, v73
    v_mfma_f32_16x16x32_bf16 v[44:47], a[96:99], a[32:35], v[44:47]
    s_waitcnt vmcnt(10)
    v_exp_f32 v74, v74
    v_cvt_pk_bf16_f32 v152, v72, v73
    v_smfmac_f32_16x16x64_bf16 v[100:103], a[252:255], a[232:239], v246
    s_barrier
    ds_read_b128 a[48:51], v240 offset:32768
    ds_read_b128 a[52:55], v241 offset:32768
    v_smfmac_f32_16x16x64_bf16 v[104:107], a[252:255], a[240:247], v246
    s_waitcnt vmcnt(7)
    ds_read_b128 a[56:59], v242 offset:32768
    ds_read_b128 a[60:63], v243 offset:32768
    s_waitcnt lgkmcnt(0)
    v_mfma_f32_16x16x32_bf16 v[212:215], a[48:51], a[32:35], 0
    buffer_load_dwordx4 v245, s[20:23], s31 offen offset:2048 nt lds
    v_mfma_f32_16x16x32_bf16 v[212:215], a[52:55], a[36:39], v[212:215]
    v_exp_f32 v75, v75
    v_mfma_f32_16x16x32_bf16 v[212:215], a[56:59], a[40:43], v[212:215]
    v_exp_f32 v76, v76
    v_cvt_pk_bf16_f32 v153, v74, v75
    v_mfma_f32_16x16x32_bf16 v[212:215], a[60:63], a[44:47], v[212:215]
    v_exp_f32 v77, v77
    v_mfma_f32_16x16x32_bf16 v[196:199], a[60:63], a[28:31], 0
    v_exp_f32 v78, v78
    v_cvt_pk_bf16_f32 v144, v76, v77
    v_mfma_f32_16x16x32_bf16 v[196:199], a[56:59], a[24:27], v[196:199]
    v_exp_f32 v79, v79
    v_mfma_f32_16x16x32_bf16 v[196:199], a[52:55], a[20:23], v[196:199]
    v_exp_f32 v80, v80
    v_cvt_pk_bf16_f32 v145, v78, v79
    v_mfma_f32_16x16x32_bf16 v[196:199], a[48:51], a[16:19], v[196:199]
    v_exp_f32 v81, v81
    v_mfma_f32_16x16x32_bf16 v[180:183], a[48:51], a[0:3], 0
    ds_read_b128 a[64:67], v240 offset:33792
    ds_read_b128 a[68:71], v241 offset:33792
    v_cvt_pk_bf16_f32 v136, v80, v81
    v_mfma_f32_16x16x32_bf16 v[180:183], a[52:55], a[4:7], v[180:183]
    s_waitcnt vmcnt(7)
    ds_read_b128 a[72:75], v242 offset:33792
    ds_read_b128 a[76:79], v243 offset:33792
    v_mfma_f32_16x16x32_bf16 v[180:183], a[56:59], a[8:11], v[180:183]
    buffer_load_dwordx4 v245, s[20:23], s31 offen offset:3072 nt lds
    v_mfma_f32_16x16x32_bf16 v[180:183], a[60:63], a[12:15], v[180:183]
    s_waitcnt lgkmcnt(0)
    v_exp_f32 v82, v82
    v_mfma_f32_16x16x32_bf16 v[184:187], a[76:79], a[12:15], 0
    s_add_u32 m0, s30, 32768
    ds_read_b128 a[80:83], v240 offset:34816
    ds_read_b128 a[84:87], v241 offset:34816
    v_mfma_f32_16x16x32_bf16 v[184:187], a[72:75], a[8:11], v[184:187]
    s_add_u32 s31, s32, 65536
    v_exp_f32 v83, v83
    v_mfma_f32_16x16x32_bf16 v[184:187], a[68:71], a[4:7], v[184:187]
    v_cvt_pk_bf16_f32 v137, v82, v83
    v_exp_f32 v0, v0
    v_mfma_f32_16x16x32_bf16 v[184:187], a[64:67], a[0:3], v[184:187]
    s_waitcnt vmcnt(4)
    ds_read_b128 a[88:91], v242 offset:34816
    ds_read_b128 a[92:95], v243 offset:34816
    v_mfma_f32_16x16x32_bf16 v[200:203], a[64:67], a[16:19], 0
    buffer_load_dwordx4 v245, s[20:23], s31 offen offset:0 nt lds
    v_mfma_f32_16x16x32_bf16 v[200:203], a[68:71], a[20:23], v[200:203]
    v_exp_f32 v1, v1
    v_mfma_f32_16x16x32_bf16 v[200:203], a[72:75], a[24:27], v[200:203]
    v_exp_f32 v84, v84
    v_cvt_pk_bf16_f32 v172, v0, v1
    v_mfma_f32_16x16x32_bf16 v[200:203], a[76:79], a[28:31], v[200:203]
    v_exp_f32 v2, v2
    v_mfma_f32_16x16x32_bf16 v[216:219], a[76:79], a[44:47], 0
    ds_read_b128 a[96:99], v240 offset:35840
    ds_read_b128 a[100:103], v241 offset:35840
    v_mfma_f32_16x16x32_bf16 v[216:219], a[72:75], a[40:43], v[216:219]
    v_exp_f32 v85, v85
    v_mfma_f32_16x16x32_bf16 v[216:219], a[68:71], a[36:39], v[216:219]
    v_exp_f32 v3, v3
    v_cvt_pk_bf16_f32 v138, v84, v85
    v_mfma_f32_16x16x32_bf16 v[216:219], a[64:67], a[32:35], v[216:219]
    s_waitcnt lgkmcnt(2)
    v_exp_f32 v86, v86
    v_cvt_pk_bf16_f32 v173, v2, v3
    v_mfma_f32_16x16x32_bf16 v[220:223], a[80:83], a[32:35], 0
    v_exp_f32 v4, v4
    v_mfma_f32_16x16x32_bf16 v[220:223], a[84:87], a[36:39], v[220:223]
    v_exp_f32 v87, v87
    v_mfma_f32_16x16x32_bf16 v[220:223], a[88:91], a[40:43], v[220:223]
    v_exp_f32 v5, v5
    v_cvt_pk_bf16_f32 v139, v86, v87
    v_mfma_f32_16x16x32_bf16 v[220:223], a[92:95], a[44:47], v[220:223]
    s_waitcnt vmcnt(4)
    ds_read_b128 a[104:107], v242 offset:35840
    ds_read_b128 a[108:111], v243 offset:35840
    v_cvt_pk_bf16_f32 v164, v4, v5
    v_mfma_f32_16x16x32_bf16 v[204:207], a[92:95], a[28:31], 0
    buffer_load_dwordx4 v245, s[20:23], s31 offen offset:1024 nt lds
    v_mfma_f32_16x16x32_bf16 v[204:207], a[88:91], a[24:27], v[204:207]
    v_exp_f32 v6, v6
    v_mfma_f32_16x16x32_bf16 v[204:207], a[84:87], a[20:23], v[204:207]
    v_exp_f32 v88, v88
    v_mfma_f32_16x16x32_bf16 v[204:207], a[80:83], a[16:19], v[204:207]
    v_exp_f32 v7, v7
    v_mfma_f32_16x16x32_bf16 v[188:191], a[80:83], a[0:3], 0
    v_exp_f32 v89, v89
    v_cvt_pk_bf16_f32 v165, v6, v7
    v_mfma_f32_16x16x32_bf16 v[188:191], a[84:87], a[4:7], v[188:191]
    v_exp_f32 v8, v8
    v_cvt_pk_bf16_f32 v146, v88, v89
    v_mfma_f32_16x16x32_bf16 v[188:191], a[88:91], a[8:11], v[188:191]
    s_waitcnt lgkmcnt(0)
    v_exp_f32 v90, v90
    v_mfma_f32_16x16x32_bf16 v[188:191], a[92:95], a[12:15], v[188:191]
    s_waitcnt vmcnt(10)
    v_exp_f32 v9, v9
    v_smfmac_f32_16x16x64_bf16 v[96:99], a[252:255], v[108:115], v246
    s_barrier
    v_smfmac_f32_16x16x64_bf16 v[100:103], a[252:255], v[116:123], v246
    v_cvt_pk_bf16_f32 v156, v8, v9
    v_mfma_f32_16x16x32_bf16 v[192:195], a[108:111], a[12:15], 0
    s_waitcnt vmcnt(4)
    ds_read_b128 a[48:51], v240 offset:49152
    ds_read_b128 a[52:55], v241 offset:49152
    v_mfma_f32_16x16x32_bf16 v[192:195], a[104:107], a[8:11], v[192:195]
    buffer_load_dwordx4 v245, s[20:23], s31 offen offset:2048 nt lds
    v_mfma_f32_16x16x32_bf16 v[192:195], a[100:103], a[4:7], v[192:195]
    v_exp_f32 v91, v91
    v_mfma_f32_16x16x32_bf16 v[192:195], a[96:99], a[0:3], v[192:195]
    ds_read_b128 a[56:59], v242 offset:49152
    ds_read_b128 a[60:63], v243 offset:49152
    v_cvt_pk_bf16_f32 v147, v90, v91
    v_mfma_f32_16x16x32_bf16 v[208:211], a[96:99], a[16:19], 0
    v_exp_f32 v10, v10
    v_mfma_f32_16x16x32_bf16 v[208:211], a[100:103], a[20:23], v[208:211]
    v_exp_f32 v92, v92
    v_mfma_f32_16x16x32_bf16 v[208:211], a[104:107], a[24:27], v[208:211]
    v_exp_f32 v11, v11
    v_mfma_f32_16x16x32_bf16 v[208:211], a[108:111], a[28:31], v[208:211]
    v_exp_f32 v93, v93
    v_cvt_pk_bf16_f32 v157, v10, v11
    v_mfma_f32_16x16x32_bf16 v[224:227], a[108:111], a[44:47], 0
    ds_read_b128 a[64:67], v240 offset:50176
    ds_read_b128 a[68:71], v241 offset:50176
    v_cvt_pk_bf16_f32 v154, v92, v93
    v_mfma_f32_16x16x32_bf16 v[224:227], a[104:107], a[40:43], v[224:227]
    v_exp_f32 v94, v94
    v_mfma_f32_16x16x32_bf16 v[224:227], a[100:103], a[36:39], v[224:227]
    v_exp_f32 v95, v95
    v_mfma_f32_16x16x32_bf16 v[224:227], a[96:99], a[32:35], v[224:227]
    s_waitcnt lgkmcnt(4)
    v_cvt_pk_bf16_f32 v155, v94, v95
    v_exp_f32 v12, v12
    v_mfma_f32_16x16x32_bf16 v[48:51], a[48:51], a[32:35], 0
    v_exp_f32 v13, v13
    v_mfma_f32_16x16x32_bf16 v[48:51], a[52:55], a[36:39], v[48:51]
    s_waitcnt lgkmcnt(2)
    v_exp_f32 v14, v14
    v_cvt_pk_bf16_f32 v158, v12, v13
    v_mfma_f32_16x16x32_bf16 v[48:51], a[56:59], a[40:43], v[48:51]
    v_exp_f32 v15, v15
    v_mfma_f32_16x16x32_bf16 v[48:51], a[60:63], a[44:47], v[48:51]
    s_waitcnt vmcnt(4)
    ds_read_b128 a[72:75], v242 offset:50176
    ds_read_b128 a[76:79], v243 offset:50176
    v_cvt_pk_bf16_f32 v159, v14, v15
    v_mfma_f32_16x16x32_bf16 v[52:55], a[60:63], a[28:31], 0
    buffer_load_dwordx4 v245, s[20:23], s31 offen offset:3072 nt lds
    v_mfma_f32_16x16x32_bf16 v[52:55], a[56:59], a[24:27], v[52:55]
    s_add_u32 m0, s30, 49152
    v_exp_f32 v16, v16
    v_mfma_f32_16x16x32_bf16 v[52:55], a[52:55], a[20:23], v[52:55]
    s_add_u32 s31, s32, 98304
    v_exp_f32 v17, v17
    v_mfma_f32_16x16x32_bf16 v[52:55], a[48:51], a[16:19], v[52:55]
    v_exp_f32 v18, v18
    v_cvt_pk_bf16_f32 v166, v16, v17
    v_mfma_f32_16x16x32_bf16 v[56:59], a[48:51], a[0:3], 0
    s_waitcnt vmcnt(5)
    ds_read_b128 a[80:83], v240 offset:51200
    ds_read_b128 a[84:87], v241 offset:51200
    v_mfma_f32_16x16x32_bf16 v[56:59], a[52:55], a[4:7], v[56:59]
    buffer_load_dwordx4 v245, s[20:23], s31 offen offset:0 nt lds
    v_mfma_f32_16x16x32_bf16 v[56:59], a[56:59], a[8:11], v[56:59]
    v_exp_f32 v19, v19
    v_mfma_f32_16x16x32_bf16 v[56:59], a[60:63], a[12:15], v[56:59]
    s_waitcnt lgkmcnt(2)
    v_exp_f32 v20, v20
    v_cvt_pk_bf16_f32 v167, v18, v19
    v_mfma_f32_16x16x32_bf16 v[60:63], a[76:79], a[12:15], 0
    v_exp_f32 v21, v21
    v_mfma_f32_16x16x32_bf16 v[60:63], a[72:75], a[8:11], v[60:63]
    v_exp_f32 v22, v22
    v_cvt_pk_bf16_f32 v174, v20, v21
    v_mfma_f32_16x16x32_bf16 v[60:63], a[68:71], a[4:7], v[60:63]
    v_exp_f32 v23, v23
    v_mfma_f32_16x16x32_bf16 v[60:63], a[64:67], a[0:3], v[60:63]
    ds_read_b128 a[88:91], v242 offset:51200
    ds_read_b128 a[92:95], v243 offset:51200
    v_cvt_pk_bf16_f32 v175, v22, v23
    v_mfma_f32_16x16x32_bf16 v[64:67], a[64:67], a[16:19], 0
    v_exp_f32 v24, v24
    v_mfma_f32_16x16x32_bf16 v[64:67], a[68:71], a[20:23], v[64:67]
    v_exp_f32 v25, v25
    v_mfma_f32_16x16x32_bf16 v[64:67], a[72:75], a[24:27], v[64:67]
    v_exp_f32 v26, v26
    v_cvt_pk_bf16_f32 v176, v24, v25
    v_mfma_f32_16x16x32_bf16 v[64:67], a[76:79], a[28:31], v[64:67]
    v_exp_f32 v27, v27
    v_mfma_f32_16x16x32_bf16 v[68:71], a[76:79], a[44:47], 0
    s_waitcnt vmcnt(5)
    ds_read_b128 a[96:99], v240 offset:52224
    ds_read_b128 a[100:103], v241 offset:52224
    v_cvt_pk_bf16_f32 v177, v26, v27
    v_mfma_f32_16x16x32_bf16 v[68:71], a[72:75], a[40:43], v[68:71]
    buffer_load_dwordx4 v245, s[20:23], s31 offen offset:1024 nt lds
    v_mfma_f32_16x16x32_bf16 v[68:71], a[68:71], a[36:39], v[68:71]
    v_exp_f32 v28, v28
    v_mfma_f32_16x16x32_bf16 v[68:71], a[64:67], a[32:35], v[68:71]
    s_waitcnt lgkmcnt(2)
    v_exp_f32 v29, v29
    v_mfma_f32_16x16x32_bf16 v[72:75], a[80:83], a[32:35], 0
    v_exp_f32 v30, v30
    v_cvt_pk_bf16_f32 v168, v28, v29
    v_mfma_f32_16x16x32_bf16 v[72:75], a[84:87], a[36:39], v[72:75]
    v_exp_f32 v31, v31
    v_mfma_f32_16x16x32_bf16 v[72:75], a[88:91], a[40:43], v[72:75]
    v_exp_f32 v32, v32
    v_cvt_pk_bf16_f32 v169, v30, v31
    v_mfma_f32_16x16x32_bf16 v[72:75], a[92:95], a[44:47], v[72:75]
    ds_read_b128 a[104:107], v242 offset:52224
    ds_read_b128 a[108:111], v243 offset:52224
    v_mfma_f32_16x16x32_bf16 v[76:79], a[92:95], a[28:31], 0
    v_exp_f32 v33, v33
    v_mfma_f32_16x16x32_bf16 v[76:79], a[88:91], a[24:27], v[76:79]
    v_exp_f32 v34, v34
    v_cvt_pk_bf16_f32 v160, v32, v33
    v_mfma_f32_16x16x32_bf16 v[76:79], a[84:87], a[20:23], v[76:79]
    v_exp_f32 v35, v35
    v_mfma_f32_16x16x32_bf16 v[76:79], a[80:83], a[16:19], v[76:79]
    v_cvt_pk_bf16_f32 v161, v34, v35
    v_exp_f32 v36, v36
    v_mfma_f32_16x16x32_bf16 v[80:83], a[80:83], a[0:3], 0
    v_exp_f32 v37, v37
    v_mfma_f32_16x16x32_bf16 v[80:83], a[84:87], a[4:7], v[80:83]
    v_exp_f32 v38, v38
    v_cvt_pk_bf16_f32 v162, v36, v37
    v_mfma_f32_16x16x32_bf16 v[80:83], a[88:91], a[8:11], v[80:83]
    s_waitcnt lgkmcnt(0)
    v_exp_f32 v39, v39
    v_mfma_f32_16x16x32_bf16 v[80:83], a[92:95], a[12:15], v[80:83]
    s_waitcnt vmcnt(5)
    v_exp_f32 v40, v40
    v_cvt_pk_bf16_f32 v163, v38, v39
    v_smfmac_f32_16x16x64_bf16 v[104:107], a[252:255], v[124:131], v246
    s_barrier
    v_smfmac_f32_16x16x64_bf16 v[96:99], a[252:255], v[132:139], v246
    buffer_load_dwordx4 v245, s[20:23], s31 offen offset:2048 nt lds
    v_mfma_f32_16x16x32_bf16 v[84:87], a[108:111], a[12:15], 0
L_stub1:
    s_cbranch_scc1 L_ret
    ds_read_b64_tr_b16 a[112:113], v228 offset:0
    ds_read_b64_tr_b16 a[114:115], v228 offset:1024
    v_mfma_f32_16x16x32_bf16 v[84:87], a[104:107], a[8:11], v[84:87]
    v_exp_f32 v41, v41
    v_mfma_f32_16x16x32_bf16 v[84:87], a[100:103], a[4:7], v[84:87]
    s_waitcnt vmcnt(5)
    ds_read_b64_tr_b16 a[116:117], v228 offset:2048
    ds_read_b64_tr_b16 a[118:119], v228 offset:3072
    v_cvt_pk_bf16_f32 v170, v40, v41
    v_mfma_f32_16x16x32_bf16 v[84:87], a[96:99], a[0:3], v[84:87]
    buffer_load_dwordx4 v245, s[20:23], s31 offen offset:3072 nt lds
    v_mfma_f32_16x16x32_bf16 v[88:91], a[96:99], a[16:19], 0
    s_add_u32 m0, s30, 65536
    ds_read_b64_tr_b16 a[120:121], v228 offset:512
    ds_read_b64_tr_b16 a[122:123], v228 offset:1536
    v_mfma_f32_16x16x32_bf16 v[88:91], a[100:103], a[20:23], v[88:91]
    s_add_u32 s31, s33, 0
    v_exp_f32 v42, v42
    v_mfma_f32_16x16x32_bf16 v[88:91], a[104:107], a[24:27], v[88:91]
    ds_read_b64_tr_b16 a[124:125], v228 offset:2560
    ds_read_b64_tr_b16 a[126:127], v228 offset:3584
    v_mfma_f32_16x16x32_bf16 v[88:91], a[108:111], a[28:31], v[88:91]
    v_exp_f32 v43, v43
    v_mfma_f32_16x16x32_bf16 v[92:95], a[108:111], a[44:47], 0
    v_exp_f32 v44, v44
    v_cvt_pk_bf16_f32 v171, v42, v43
    v_mfma_f32_16x16x32_bf16 v[92:95], a[104:107], a[40:43], v[92:95]
    v_exp_f32 v45, v45
    v_mfma_f32_16x16x32_bf16 v[92:95], a[100:103], a[36:39], v[92:95]
    ds_read_b64_tr_b16 a[140:141], v229 offset:2560
    ds_read_b64_tr_b16 a[142:143], v229 offset:3584
    v_cvt_pk_bf16_f32 v178, v44, v45
    v_mfma_f32_16x16x32_bf16 v[92:95], a[96:99], a[32:35], v[92:95]
    s_waitcnt lgkmcnt(6)
    v_exp_f32 v46, v46
    v_mfma_f32_16x16x32_bf16 v[0:3], a[112:115], a[192:195], 0
    s_waitcnt vmcnt(5)
    v_exp_f32 v47, v47
    v_mfma_f32_16x16x32_bf16 v[0:3], a[116:119], a[196:199], v[0:3]
    s_waitcnt lgkmcnt(2)
    ds_read_b64_tr_b16 a[136:137], v229 offset:512
    ds_read_b64_tr_b16 a[138:139], v229 offset:1536
    v_cvt_pk_bf16_f32 v179, v46, v47
    v_mfma_f32_16x16x32_bf16 v[0:3], a[120:123], a[216:219], v[0:3]
    buffer_load_dwordx4 v245, s[20:23], s31 offen offset:0 nt lds
    v_mfma_f32_16x16x32_bf16 v[0:3], a[124:127], a[220:223], v[0:3]
    v_exp_f32 v180, v180
    v_mfma_f32_16x16x32_bf16 v[4:7], a[124:127], a[212:215], 0
    ds_read_b64_tr_b16 a[132:133], v229 offset:2048
    ds_read_b64_tr_b16 a[134:135], v229 offset:3072
    v_mfma_f32_16x16x32_bf16 v[4:7], a[120:123], a[208:211], v[4:7]
    v_exp_f32 v181, v181
    v_mfma_f32_16x16x32_bf16 v[4:7], a[116:119], a[188:191], v[4:7]
    v_exp_f32 v196, v196
    v_cvt_pk_bf16_f32 v180, v180, v181
    v_mfma_f32_16x16x32_bf16 v[4:7], a[112:115], a[184:187], v[4:7]
    ds_read_b64_tr_b16 a[128:129], v229 offset:0
    ds_read_b64_tr_b16 a[130:131], v229 offset:1024
    v_mfma_f32_16x16x32_bf16 v[8:11], a[112:115], a[176:179], 0
    v_exp_f32 v182, v182
    v_mfma_f32_16x16x32_bf16 v[8:11], a[116:119], a[180:183], v[8:11]
    v_exp_f32 v197, v197
    v_mfma_f32_16x16x32_bf16 v[8:11], a[120:123], a[200:203], v[8:11]
    ds_read_b64_tr_b16 a[144:145], v230 offset:0
    ds_read_b64_tr_b16 a[146:147], v230 offset:1024
    v_cvt_pk_bf16_f32 v196, v196, v197
    v_mfma_f32_16x16x32_bf16 v[8:11], a[124:127], a[204:207], v[8:11]
    s_waitcnt lgkmcnt(6)
    v_exp_f32 v183, v183
    v_mfma_f32_16x16x32_bf16 v[12:15], a[140:143], a[204:207], 0
    s_waitcnt vmcnt(5)
    v_exp_f32 v198, v198
    v_cvt_pk_bf16_f32 v181, v182, v183
    v_mfma_f32_16x16x32_bf16 v[12:15], a[136:139], a[200:203], v[12:15]
    s_waitcnt lgkmcnt(2)
    ds_read_b64_tr_b16 a[148:149], v230 offset:2048
    ds_read_b64_tr_b16 a[150:151], v230 offset:3072
    v_mfma_f32_16x16x32_bf16 v[12:15], a[132:135], a[180:183], v[12:15]
    buffer_load_dwordx4 v245, s[20:23], s31 offen offset:1024 nt lds
    v_mfma_f32_16x16x32_bf16 v[12:15], a[128:131], a[176:179], v[12:15]
    v_exp_f32 v199, v199
    v_mfma_f32_16x16x32_bf16 v[16:19], a[128:131], a[184:187], 0
    ds_read_b64_tr_b16 a[152:153], v230 offset:512
    ds_read_b64_tr_b16 a[154:155], v230 offset:1536
    v_cvt_pk_bf16_f32 v197, v198, v199
    v_mfma_f32_16x16x32_bf16 v[16:19], a[132:135], a[188:191], v[16:19]
    v_exp_f32 v184, v184
    v_mfma_f32_16x16x32_bf16 v[16:19], a[136:139], a[208:211], v[16:19]
    v_exp_f32 v185, v185
    v_mfma_f32_16x16x32_bf16 v[16:19], a[140:143], a[212:215], v[16:19]
    ds_read_b64_tr_b16 a[156:157], v230 offset:2560
    ds_read_b64_tr_b16 a[158:159], v230 offset:3584
    v_cvt_pk_bf16_f32 v182, v184, v185
    v_mfma_f32_16x16x32_bf16 v[20:23], a[140:143], a[220:223], 0
    v_exp_f32 v200, v200
    v_mfma_f32_16x16x32_bf16 v[20:23], a[136:139], a[216:219], v[20:23]
    ds_read_b64_tr_b16 a[172:173], v231 offset:2560
    ds_read_b64_tr_b16 a[174:175], v231 offset:3584
    v_mfma_f32_16x16x32_bf16 v[20:23], a[132:135], a[196:199], v[20:23]
    s_waitcnt vmcnt(5)
    v_exp_f32 v186, v186
    v_mfma_f32_16x16x32_bf16 v[20:23], a[128:131], a[192:195], v[20:23]
    s_waitcnt lgkmcnt(6)
    ds_read_b64_tr_b16 a[168:169], v231 offset:512
    ds_read_b64_tr_b16 a[170:171], v231 offset:1536
    v_mfma_f32_16x16x32_bf16 v[24:27], a[144:147], a[192:195], 0
    buffer_load_dwordx4 v245, s[20:23], s31 offen offset:2048 nt lds
    v_mfma_f32_16x16x32_bf16 v[24:27], a[148:151], a[196:199], v[24:27]
    s_waitcnt lgkmcnt(4)
    ds_read_b64_tr_b16 a[164:165], v231 offset:2048
    ds_read_b64_tr_b16 a[166:167], v231 offset:3072
    v_mfma_f32_16x16x32_bf16 v[24:27], a[152:155], a[216:219], v[24:27]
    v_exp_f32 v201, v201
    v_mfma_f32_16x16x32_bf16 v[24:27], a[156:159], a[220:223], v[24:27]
    ds_read_b64_tr_b16 a[160:161], v231 offset:0
    ds_read_b64_tr_b16 a[162:163], v231 offset:1024
    v_cvt_pk_bf16_f32 v198, v200, v201
    v_mfma_f32_16x16x32_bf16 v[28:31], a[156:159], a[212:215], 0
    v_exp_f32 v187, v187
    v_mfma_f32_16x16x32_bf16 v[28:31], a[152:155], a[208:211], v[28:31]
    v_exp_f32 v202, v202
    v_cvt_pk_bf16_f32 v183, v186, v187
    v_mfma_f32_16x16x32_bf16 v[28:31], a[148:151], a[188:191], v[28:31]
    v_exp_f32 v203, v203
    v_mfma_f32_16x16x32_bf16 v[28:31], a[144:147], a[184:187], v[28:31]
    v_exp_f32 v188, v188
    v_cvt_pk_bf16_f32 v199, v202, v203
    v_mfma_f32_16x16x32_bf16 v[32:35], a[144:147], a[176:179], 0
    v_exp_f32 v189, v189
    v_mfma_f32_16x16x32_bf16 v[32:35], a[148:151], a[180:183], v[32:35]
    v_exp_f32 v204, v204
    v_cvt_pk_bf16_f32 v184, v188, v189
    v_mfma_f32_16x16x32_bf16 v[32:35], a[152:155], a[200:203], v[32:35]
    s_waitcnt lgkmcnt(0)
    v_exp_f32 v190, v190
    v_mfma_f32_16x16x32_bf16 v[32:35], a[156:159], a[204:207], v[32:35]
    s_waitcnt vmcnt(5)
    v_exp_f32 v205, v205
    v_smfmac_f32_16x16x64_bf16 v[100:103], a[252:255], v[140:147], v246
    s_barrier
    v_smfmac_f32_16x16x64_bf16 v[104:107], a[252:255], v[148:155], v246
    buffer_load_dwordx4 v245, s[20:23], s31 offen offset:3072 nt lds
    v_mfma_f32_16x16x32_bf16 v[36:39], a[172:175], a[204:207], 0
    s_add_u32 m0, s30, 81920
    ds_read_b64_tr_b16 a[48:49], v228 offset:16384
    ds_read_b64_tr_b16 a[50:51], v228 offset:17408
    v_cvt_pk_bf16_f32 v200, v204, v205
    v_mfma_f32_16x16x32_bf16 v[36:39], a[168:171], a[200:203], v[36:39]
    s_add_u32 s31, s33, 32768
    v_exp_f32 v191, v191
    v_mfma_f32_16x16x32_bf16 v[36:39], a[164:167], a[180:183], v[36:39]
    ds_read_b64_tr_b16 a[52:53], v228 offset:18432
    ds_read_b64_tr_b16 a[54:55], v228 offset:19456
    v_cvt_pk_bf16_f32 v185, v190, v191
    v_mfma_f32_16x16x32_bf16 v[36:39], a[160:163], a[176:179], v[36:39]
    v_exp_f32 v206, v206
    v_mfma_f32_16x16x32_bf16 v[40:43], a[160:163], a[184:187], 0
    ds_read_b64_tr_b16 a[56:57], v228 offset:16896
    ds_read_b64_tr_b16 a[58:59], v228 offset:17920
    v_mfma_f32_16x16x32_bf16 v[40:43], a[164:167], a[188:191], v[40:43]
    v_exp_f32 v212, v212
    v_mfma_f32_16x16x32_bf16 v[40:43], a[168:171], a[208:211], v[40:43]
    s_waitcnt vmcnt(5)
    ds_read_b64_tr_b16 a[60:61], v228 offset:18944
    ds_read_b64_tr_b16 a[62:63], v228 offset:19968
    v_mfma_f32_16x16x32_bf16 v[40:43], a[172:175], a[212:215], v[40:43]
    buffer_load_dwordx4 v245, s[20:23], s31 offen offset:0 nt lds
    v_mfma_f32_16x16x32_bf16 v[44:47], a[172:175], a[220:223], 0
    v_exp_f32 v207, v207
    v_mfma_f32_16x16x32_bf16 v[44:47], a[168:171], a[216:219], v[44:47]
    v_exp_f32 v213, v213
    v_cvt_pk_bf16_f32 v201, v206, v207
    v_mfma_f32_16x16x32_bf16 v[44:47], a[164:167], a[196:199], v[44:47]
    ds_read_b64_tr_b16 a[76:77], v229 offset:18944
    ds_read_b64_tr_b16 a[78:79], v229 offset:19968
    v_cvt_pk_bf16_f32 v212, v212, v213
    v_mfma_f32_16x16x32_bf16 v[44:47], a[160:163], a[192:195], v[44:47]
    s_waitcnt lgkmcnt(6)
    v_exp_f32 v192, v192
    v_mfma_f32_16x16x32_bf16 v[0:3], a[48:51], a[240:243], v[0:3]
    v_exp_f32 v214, v214
    v_mfma_f32_16x16x32_bf16 v[0:3], a[52:55], a[244:247], v[0:3]
    s_waitcnt lgkmcnt(2)
    ds_read_b64_tr_b16 a[72:73], v229 offset:16896
    ds_read_b64_tr_b16 a[74:75], v229 offset:17920
    v_mfma_f32_16x16x32_bf16 v[0:3], a[56:59], v[124:127], v[0:3]
    v_exp_f32 v193, v193
    v_mfma_f32_16x16x32_bf16 v[0:3], a[60:63], v[128:131], v[0:3]
    v_exp_f32 v208, v208
    v_cvt_pk_bf16_f32 v186, v192, v193
    v_mfma_f32_16x16x32_bf16 v[4:7], a[60:63], v[120:123], v[4:7]
    ds_read_b64_tr_b16 a[68:69], v229 offset:18432
    ds_read_b64_tr_b16 a[70:71], v229 offset:19456
    v_mfma_f32_16x16x32_bf16 v[4:7], a[56:59], v[116:119], v[4:7]
    v_exp_f32 v215, v215
    v_mfma_f32_16x16x32_bf16 v[4:7], a[52:55], a[236:239], v[4:7]
    v_exp_f32 v194, v194
    v_cvt_pk_bf16_f32 v213, v214, v215
    v_mfma_f32_16x16x32_bf16 v[4:7], a[48:51], a[232:235], v[4:7]
    s_waitcnt vmcnt(5)
    ds_read_b64_tr_b16 a[64:65], v229 offset:16384
    ds_read_b64_tr_b16 a[66:67], v229 offset:17408
    v_mfma_f32_16x16x32_bf16 v[8:11], a[48:51], a[224:227], v[8:11]
    buffer_load_dwordx4 v245, s[20:23], s31 offen offset:1024 nt lds
    v_mfma_f32_16x16x32_bf16 v[8:11], a[52:55], a[228:231], v[8:11]
    v_exp_f32 v209, v209
    v_mfma_f32_16x16x32_bf16 v[8:11], a[56:59], v[108:111], v[8:11]
    ds_read_b64_tr_b16 a[80:81], v230 offset:16384
    ds_read_b64_tr_b16 a[82:83], v230 offset:17408
    v_cvt_pk_bf16_f32 v202, v208, v209
    v_mfma_f32_16x16x32_bf16 v[8:11], a[60:63], v[112:115], v[8:11]
    s_waitcnt lgkmcnt(6)
    v_exp_f32 v195, v195
    v_mfma_f32_16x16x32_bf16 v[12:15], a[76:79], v[112:115], v[12:15]
    v_exp_f32 v210, v210
    v_cvt_pk_bf16_f32 v187, v194, v195
    v_mfma_f32_16x16x32_bf16 v[12:15], a[72:75], v[108:111], v[12:15]
    s_waitcnt lgkmcnt(2)
    ds_read_b64_tr_b16 a[84:85], v230 offset:18432
    ds_read_b64_tr_b16 a[86:87], v230 offset:19456
    v_mfma_f32_16x16x32_bf16 v[12:15], a[68:71], a[228:231], v[12:15]
    v_exp_f32 v216, v216
    v_mfma_f32_16x16x32_bf16 v[12:15], a[64:67], a[224:227], v[12:15]
    v_exp_f32 v211, v211
    v_mfma_f32_16x16x32_bf16 v[16:19], a[64:67], a[232:235], v[16:19]
    s_waitcnt vmcnt(5)
    ds_read_b64_tr_b16 a[88:89], v230 offset:16896
    ds_read_b64_tr_b16 a[90:91], v230 offset:17920
    v_cvt_pk_bf16_f32 v203, v210, v211
    v_mfma_f32_16x16x32_bf16 v[16:19], a[68:71], a[236:239], v[16:19]
    buffer_load_dwordx4 v245, s[20:23], s31 offen offset:2048 nt lds
    v_mfma_f32_16x16x32_bf16 v[16:19], a[72:75], v[116:119], v[16:19]
    v_exp_f32 v217, v217
    v_mfma_f32_16x16x32_bf16 v[16:19], a[76:79], v[120:123], v[16:19]
    ds_read_b64_tr_b16 a[92:93], v230 offset:18944
    ds_read_b64_tr_b16 a[94:95], v230 offset:19968
    v_cvt_pk_bf16_f32 v214, v216, v217
    v_mfma_f32_16x16x32_bf16 v[20:23], a[76:79], v[128:131], v[20:23]
    v_exp_f32 v218, v218
    v_mfma_f32_16x16x32_bf16 v[20:23], a[72:75], v[124:127], v[20:23]
    ds_read_b64_tr_b16 a[108:109], v231 offset:18944
    ds_read_b64_tr_b16 a[110:111], v231 offset:19968
    v_mfma_f32_16x16x32_bf16 v[20:23], a[68:71], a[244:247], v[20:23]
    v_exp_f32 v219, v219
    v_mfma_f32_16x16x32_bf16 v[20:23], a[64:67], a[240:243], v[20:23]
    s_waitcnt lgkmcnt(6)
    ds_read_b64_tr_b16 a[104:105], v231 offset:16896
    ds_read_b64_tr_b16 a[106:107], v231 offset:17920
    v_cvt_pk_bf16_f32 v215, v218, v219
    v_mfma_f32_16x16x32_bf16 v[24:27], a[80:83], a[240:243], v[24:27]
    v_exp_f32 v220, v220
    v_mfma_f32_16x16x32_bf16 v[24:27], a[84:87], a[244:247], v[24:27]
    s_waitcnt lgkmcnt(4)
    ds_read_b64_tr_b16 a[100:101], v231 offset:18432
    ds_read_b64_tr_b16 a[102:103], v231 offset:19456
    v_mfma_f32_16x16x32_bf16 v[24:27], a[88:91], v[124:127], v[24:27]
    v_exp_f32 v221, v221
    v_mfma_f32_16x16x32_bf16 v[24:27], a[92:95], v[128:131], v[24:27]
    s_waitcnt vmcnt(5)
    ds_read_b64_tr_b16 a[96:97], v231 offset:16384
    ds_read_b64_tr_b16 a[98:99], v231 offset:17408
    v_cvt_pk_bf16_f32 v216, v220, v221
    v_mfma_f32_16x16x32_bf16 v[28:31], a[92:95], v[120:123], v[28:31]
    buffer_load_dwordx4 v245, s[20:23], s31 offen offset:3072 nt lds
    v_mfma_f32_16x16x32_bf16 v[28:31], a[88:91], v[116:119], v[28:31]
    s_add_u32 m0, s30, 98304
    v_exp_f32 v222, v222
    v_mfma_f32_16x16x32_bf16 v[28:31], a[84:87], a[236:239], v[28:31]
    s_add_u32 s31, s33, 65536
    v_exp_f32 v223, v223
    v_mfma_f32_16x16x32_bf16 v[28:31], a[80:83], a[232:235], v[28:31]
    v_cvt_pk_bf16_f32 v217, v222, v223
    v_exp_f32 v224, v224
    v_mfma_f32_16x16x32_bf16 v[32:35], a[80:83], a[224:227], v[32:35]
    v_exp_f32 v225, v225
    v_mfma_f32_16x16x32_bf16 v[32:35], a[84:87], a[228:231], v[32:35]
    v_exp_f32 v226, v226
    v_cvt_pk_bf16_f32 v218, v224, v225
    v_mfma_f32_16x16x32_bf16 v[32:35], a[88:91], v[108:111], v[32:35]
    s_waitcnt lgkmcnt(0)
    v_exp_f32 v227, v227
    v_mfma_f32_16x16x32_bf16 v[32:35], a[92:95], v[112:115], v[32:35]
    s_waitcnt vmcnt(12)
    v_cvt_pk_bf16_f32 v219, v226, v227
    v_exp_f32 v48, v48
    v_smfmac_f32_16x16x64_bf16 v[96:99], a[252:255], v[156:163], v246
    s_barrier
    v_smfmac_f32_16x16x64_bf16 v[100:103], a[252:255], v[164:171], v246
    v_mfma_f32_16x16x32_bf16 v[36:39], a[108:111], v[112:115], v[36:39]
    s_waitcnt vmcnt(5)
    ds_read_b64_tr_b16 a[112:113], v228 offset:32768
    ds_read_b64_tr_b16 a[114:115], v228 offset:33792
    v_mfma_f32_16x16x32_bf16 v[36:39], a[104:107], v[108:111], v[36:39]
    buffer_load_dwordx4 v245, s[20:23], s31 offen offset:0 nt lds
    v_mfma_f32_16x16x32_bf16 v[36:39], a[100:103], a[228:231], v[36:39]
    ds_read_b64_tr_b16 a[116:117], v228 offset:34816
    ds_read_b64_tr_b16 a[118:119], v228 offset:35840
    v_mfma_f32_16x16x32_bf16 v[36:39], a[96:99], a[224:227], v[36:39]
    v_exp_f32 v49, v49
    v_mfma_f32_16x16x32_bf16 v[40:43], a[96:99], a[232:235], v[40:43]
    ds_read_b64_tr_b16 a[120:121], v228 offset:33280
    ds_read_b64_tr_b16 a[122:123], v228 offset:34304
    v_cvt_pk_bf16_f32 v220, v48, v49
    v_mfma_f32_16x16x32_bf16 v[40:43], a[100:103], a[236:239], v[40:43]
    v_exp_f32 v52, v52
    v_mfma_f32_16x16x32_bf16 v[40:43], a[104:107], v[116:119], v[40:43]
    ds_read_b64_tr_b16 a[124:125], v228 offset:35328
    ds_read_b64_tr_b16 a[126:127], v228 offset:36352
    v_mfma_f32_16x16x32_bf16 v[40:43], a[108:111], v[120:123], v[40:43]
    v_exp_f32 v50, v50
    v_mfma_f32_16x16x32_bf16 v[44:47], a[108:111], v[128:131], v[44:47]
    v_exp_f32 v53, v53
    v_mfma_f32_16x16x32_bf16 v[44:47], a[104:107], v[124:127], v[44:47]
    v_exp_f32 v51, v51
    v_cvt_pk_bf16_f32 v204, v52, v53
    v_mfma_f32_16x16x32_bf16 v[44:47], a[100:103], a[244:247], v[44:47]
    ds_read_b64_tr_b16 a[140:141], v229 offset:35328
    ds_read_b64_tr_b16 a[142:143], v229 offset:36352
    v_cvt_pk_bf16_f32 v221, v50, v51
    v_mfma_f32_16x16x32_bf16 v[44:47], a[96:99], a[240:243], v[44:47]
    s_waitcnt lgkmcnt(6)
    v_exp_f32 v56, v56
    v_mfma_f32_16x16x32_bf16 v[0:3], a[112:115], v[148:151], v[0:3]
    s_waitcnt vmcnt(5)
    v_exp_f32 v54, v54
    v_mfma_f32_16x16x32_bf16 v[0:3], a[116:119], v[152:155], v[0:3]
    s_waitcnt lgkmcnt(2)
    ds_read_b64_tr_b16 a[136:137], v229 offset:33280
    ds_read_b64_tr_b16 a[138:139], v229 offset:34304
    v_mfma_f32_16x16x32_bf16 v[0:3], a[120:123], v[172:175], v[0:3]
    buffer_load_dwordx4 v245, s[20:23], s31 offen offset:1024 nt lds
    v_mfma_f32_16x16x32_bf16 v[0:3], a[124:127], v[176:179], v[0:3]
    v_exp_f32 v57, v57
    v_mfma_f32_16x16x32_bf16 v[4:7], a[124:127], v[168:171], v[4:7]
    ds_read_b64_tr_b16 a[132:133], v229 offset:34816
    ds_read_b64_tr_b16 a[134:135], v229 offset:35840
    v_cvt_pk_bf16_f32 v188, v56, v57
    v_mfma_f32_16x16x32_bf16 v[4:7], a[120:123], v[164:167], v[4:7]
    v_exp_f32 v55, v55
    v_mfma_f32_16x16x32_bf16 v[4:7], a[116:119], v[144:147], v[4:7]
    v_exp_f32 v68, v68
    v_cvt_pk_bf16_f32 v205, v54, v55
    v_mfma_f32_16x16x32_bf16 v[4:7], a[112:115], v[140:143], v[4:7]
    ds_read_b64_tr_b16 a[128:129], v229 offset:32768
    ds_read_b64_tr_b16 a[130:131], v229 offset:33792
    v_mfma_f32_16x16x32_bf16 v[8:11], a[112:115], v[132:135], v[8:11]
    v_exp_f32 v58, v58
    v_mfma_f32_16x16x32_bf16 v[8:11], a[116:119], v[136:139], v[8:11]
    v_exp_f32 v69, v69
    v_mfma_f32_16x16x32_bf16 v[8:11], a[120:123], v[156:159], v[8:11]
    ds_read_b64_tr_b16 a[144:145], v230 offset:32768
    ds_read_b64_tr_b16 a[146:147], v230 offset:33792
    v_cvt_pk_bf16_f32 v222, v68, v69
    v_mfma_f32_16x16x32_bf16 v[8:11], a[124:127], v[160:163], v[8:11]
    s_waitcnt lgkmcnt(6)
    v_exp_f32 v59, v59
    v_mfma_f32_16x16x32_bf16 v[12:15], a[140:143], v[160:163], v[12:15]
    s_waitcnt vmcnt(5)
    v_exp_f32 v64, v64
    v_cvt_pk_bf16_f32 v189, v58, v59
    v_mfma_f32_16x16x32_bf16 v[12:15], a[136:139], v[156:159], v[12:15]
    s_waitcnt lgkmcnt(2)
    ds_read_b64_tr_b16 a[148:149], v230 offset:34816
    ds_read_b64_tr_b16 a[150:151], v230 offset:35840
    v_mfma_f32_16x16x32_bf16 v[12:15], a[132:135], v[136:139], v[12:15]
    buffer_load_dwordx4 v245, s[20:23], s31 offen offset:2048 nt lds
    v_mfma_f32_16x16x32_bf16 v[12:15], a[128:131], v[132:135], v[12:15]
    v_exp_f32 v70, v70
    v_mfma_f32_16x16x32_bf16 v[16:19], a[128:131], v[140:143], v[16:19]
    ds_read_b64_tr_b16 a[152:153], v230 offset:33280
    ds_read_b64_tr_b16 a[154:155], v230 offset:34304
    v_mfma_f32_16x16x32_bf16 v[16:19], a[132:135], v[144:147], v[16:19]
    v_exp_f32 v65, v65
    v_mfma_f32_16x16x32_bf16 v[16:19], a[136:139], v[164:167], v[16:19]
    v_exp_f32 v71, v71
    v_cvt_pk_bf16_f32 v206, v64, v65
    v_mfma_f32_16x16x32_bf16 v[16:19], a[140:143], v[168:171], v[16:19]
    ds_read_b64_tr_b16 a[156:157], v230 offset:35328
    ds_read_b64_tr_b16 a[158:159], v230 offset:36352
    v_cvt_pk_bf16_f32 v223, v70, v71
    v_mfma_f32_16x16x32_bf16 v[20:23], a[140:143], v[176:179], v[20:23]
    v_exp_f32 v60, v60
    v_mfma_f32_16x16x32_bf16 v[20:23], a[136:139], v[172:175], v[20:23]
    ds_read_b64_tr_b16 a[172:173], v231 offset:35328
    ds_read_b64_tr_b16 a[174:175], v231 offset:36352
    v_mfma_f32_16x16x32_bf16 v[20:23], a[132:135], v[152:155], v[20:23]
    s_waitcnt vmcnt(5)
    v_exp_f32 v66, v66
    v_mfma_f32_16x16x32_bf16 v[20:23], a[128:131], v[148:151], v[20:23]
    s_waitcnt lgkmcnt(6)
    ds_read_b64_tr_b16 a[168:169], v231 offset:33280
    ds_read_b64_tr_b16 a[170:171], v231 offset:34304
    v_mfma_f32_16x16x32_bf16 v[24:27], a[144:147], v[148:151], v[24:27]
    buffer_load_dwordx4 v245, s[20:23], s31 offen offset:3072 nt lds
    v_mfma_f32_16x16x32_bf16 v[24:27], a[148:151], v[152:155], v[24:27]
    s_waitcnt lgkmcnt(4)
    ds_read_b64_tr_b16 a[164:165], v231 offset:34816
    ds_read_b64_tr_b16 a[166:167], v231 offset:35840
    v_mfma_f32_16x16x32_bf16 v[24:27], a[152:155], v[172:175], v[24:27]
    s_add_u32 m0, s30, 114688
    v_exp_f32 v61, v61
    v_mfma_f32_16x16x32_bf16 v[24:27], a[156:159], v[176:179], v[24:27]
    s_add_u32 s31, s33, 98304
    ds_read_b64_tr_b16 a[160:161], v231 offset:32768
    ds_read_b64_tr_b16 a[162:163], v231 offset:33792
    v_cvt_pk_bf16_f32 v190, v60, v61
    v_mfma_f32_16x16x32_bf16 v[28:31], a[156:159], v[168:171], v[28:31]
    v_exp_f32 v67, v67
    v_mfma_f32_16x16x32_bf16 v[28:31], a[152:155], v[164:167], v[28:31]
    v_exp_f32 v72, v72
    v_cvt_pk_bf16_f32 v207, v66, v67
    v_mfma_f32_16x16x32_bf16 v[28:31], a[148:151], v[144:147], v[28:31]
    v_exp_f32 v62, v62
    v_mfma_f32_16x16x32_bf16 v[28:31], a[144:147], v[140:143], v[28:31]
    v_exp_f32 v73, v73
    v_mfma_f32_16x16x32_bf16 v[32:35], a[144:147], v[132:135], v[32:35]
    v_exp_f32 v63, v63
    v_cvt_pk_bf16_f32 v224, v72, v73
    v_mfma_f32_16x16x32_bf16 v[32:35], a[148:151], v[136:139], v[32:35]
    v_exp_f32 v76, v76
    v_cvt_pk_bf16_f32 v191, v62, v63
    v_mfma_f32_16x16x32_bf16 v[32:35], a[152:155], v[156:159], v[32:35]
    v_exp_f32 v74, v74
    v_mfma_f32_16x16x32_bf16 v[32:35], a[156:159], v[160:163], v[32:35]
    s_waitcnt lgkmcnt(0)
    v_exp_f32 v77, v77
    v_smfmac_f32_16x16x64_bf16 v[104:107], a[252:255], v[172:179], v246
    s_waitcnt vmcnt(5)
    v_cvt_pk_bf16_f32 v208, v76, v77
    v_smfmac_f32_16x16x64_bf16 v[96:99], a[252:255], v[180:187], v246
    s_barrier
    v_smfmac_f32_16x16x64_bf16 v[100:103], a[252:255], v[196:203], v246
    buffer_load_dwordx4 v245, s[20:23], s31 offen offset:0 nt lds
    v_mfma_f32_16x16x32_bf16 v[36:39], a[172:175], v[160:163], v[36:39]
    ds_read_b64_tr_b16 a[48:49], v228 offset:49152
    ds_read_b64_tr_b16 a[50:51], v228 offset:50176
    v_mfma_f32_16x16x32_bf16 v[36:39], a[168:171], v[156:159], v[36:39]
    v_exp_f32 v75, v75
    v_mfma_f32_16x16x32_bf16 v[36:39], a[164:167], v[136:139], v[36:39]
    ds_read_b64_tr_b16 a[52:53], v228 offset:51200
    ds_read_b64_tr_b16 a[54:55], v228 offset:52224
    v_cvt_pk_bf16_f32 v225, v74, v75
    v_mfma_f32_16x16x32_bf16 v[36:39], a[160:163], v[132:135], v[36:39]
    v_exp_f32 v80, v80
    v_mfma_f32_16x16x32_bf16 v[40:43], a[160:163], v[140:143], v[40:43]
    ds_read_b64_tr_b16 a[68:69], v229 offset:51200
    ds_read_b64_tr_b16 a[70:71], v229 offset:52224
    v_mfma_f32_16x16x32_bf16 v[40:43], a[164:167], v[144:147], v[40:43]
    v_exp_f32 v78, v78
    v_mfma_f32_16x16x32_bf16 v[40:43], a[168:171], v[164:167], v[40:43]
    ds_read_b64_tr_b16 a[64:65], v229 offset:49152
    ds_read_b64_tr_b16 a[66:67], v229 offset:50176
    v_mfma_f32_16x16x32_bf16 v[40:43], a[172:175], v[168:171], v[40:43]
    v_exp_f32 v81, v81
    v_mfma_f32_16x16x32_bf16 v[44:47], a[172:175], v[176:179], v[44:47]
    v_exp_f32 v79, v79
    v_cvt_pk_bf16_f32 v192, v80, v81
    v_mfma_f32_16x16x32_bf16 v[44:47], a[168:171], v[172:175], v[44:47]
    v_exp_f32 v92, v92
    v_cvt_pk_bf16_f32 v209, v78, v79
    v_mfma_f32_16x16x32_bf16 v[44:47], a[164:167], v[152:155], v[44:47]
    ds_read_b64_tr_b16 a[80:81], v230 offset:49152
    ds_read_b64_tr_b16 a[82:83], v230 offset:50176
    v_mfma_f32_16x16x32_bf16 v[44:47], a[160:163], v[148:151], v[44:47]
    s_waitcnt lgkmcnt(6)
    v_exp_f32 v82, v82
    v_mfma_f32_16x16x32_bf16 v[0:3], a[48:51], v[212:215], v[0:3]
    v_exp_f32 v93, v93
    v_mfma_f32_16x16x32_bf16 v[0:3], a[52:55], v[216:219], v[0:3]
    s_waitcnt vmcnt(5)
    ds_read_b64_tr_b16 a[84:85], v230 offset:51200
    ds_read_b64_tr_b16 a[86:87], v230 offset:52224
    v_cvt_pk_bf16_f32 v226, v92, v93
    v_mfma_f32_16x16x32_bf16 v[4:7], a[52:55], v[200:203], v[4:7]
    buffer_load_dwordx4 v245, s[20:23], s31 offen offset:1024 nt lds
    v_mfma_f32_16x16x32_bf16 v[4:7], a[48:51], v[196:199], v[4:7]
    v_exp_f32 v83, v83
    v_mfma_f32_16x16x32_bf16 v[8:11], a[48:51], v[180:183], v[8:11]
    ds_read_b64_tr_b16 a[100:101], v231 offset:51200
    ds_read_b64_tr_b16 a[102:103], v231 offset:52224
    v_cvt_pk_bf16_f32 v193, v82, v83
    v_mfma_f32_16x16x32_bf16 v[8:11], a[52:55], v[184:187], v[8:11]
    s_waitcnt lgkmcnt(6)
    v_exp_f32 v88, v88
    v_mfma_f32_16x16x32_bf16 v[12:15], a[68:71], v[184:187], v[12:15]
    v_exp_f32 v94, v94
    v_mfma_f32_16x16x32_bf16 v[12:15], a[64:67], v[180:183], v[12:15]
    ds_read_b64_tr_b16 a[96:97], v231 offset:49152
    ds_read_b64_tr_b16 a[98:99], v231 offset:50176
    v_mfma_f32_16x16x32_bf16 v[16:19], a[64:67], v[196:199], v[16:19]
    v_exp_f32 v89, v89
    v_mfma_f32_16x16x32_bf16 v[16:19], a[68:71], v[200:203], v[16:19]
    v_exp_f32 v95, v95
    v_cvt_pk_bf16_f32 v210, v88, v89
    v_mfma_f32_16x16x32_bf16 v[20:23], a[68:71], v[216:219], v[20:23]
    ds_read_b64_tr_b16 a[56:57], v228 offset:49664
    ds_read_b64_tr_b16 a[58:59], v228 offset:50688
    v_cvt_pk_bf16_f32 v227, v94, v95
    v_mfma_f32_16x16x32_bf16 v[20:23], a[64:67], v[212:215], v[20:23]
    s_waitcnt lgkmcnt(6)
    v_exp_f32 v84, v84
    v_mfma_f32_16x16x32_bf16 v[24:27], a[80:83], v[212:215], v[24:27]
    v_exp_f32 v90, v90
    v_mfma_f32_16x16x32_bf16 v[24:27], a[84:87], v[216:219], v[24:27]
    s_waitcnt vmcnt(5)
    ds_read_b64_tr_b16 a[60:61], v228 offset:51712
    ds_read_b64_tr_b16 a[62:63], v228 offset:52736
    v_mfma_f32_16x16x32_bf16 v[28:31], a[84:87], v[200:203], v[28:31]
    buffer_load_dwordx4 v245, s[20:23], s31 offen offset:2048 nt lds
    v_mfma_f32_16x16x32_bf16 v[28:31], a[80:83], v[196:199], v[28:31]
    v_exp_f32 v85, v85
    v_mfma_f32_16x16x32_bf16 v[32:35], a[80:83], v[180:183], v[32:35]
    ds_read_b64_tr_b16 a[76:77], v229 offset:51712
    ds_read_b64_tr_b16 a[78:79], v229 offset:52736
    v_cvt_pk_bf16_f32 v194, v84, v85
    v_mfma_f32_16x16x32_bf16 v[32:35], a[84:87], v[184:187], v[32:35]
    s_waitcnt lgkmcnt(6)
    v_exp_f32 v91, v91
    v_mfma_f32_16x16x32_bf16 v[36:39], a[100:103], v[184:187], v[36:39]
    v_exp_f32 v86, v86
    v_cvt_pk_bf16_f32 v211, v90, v91
    v_mfma_f32_16x16x32_bf16 v[36:39], a[96:99], v[180:183], v[36:39]
    ds_read_b64_tr_b16 a[72:73], v229 offset:49664
    ds_read_b64_tr_b16 a[74:75], v229 offset:50688
    v_mfma_f32_16x16x32_bf16 v[40:43], a[96:99], v[196:199], v[40:43]
    v_exp_f32 v87, v87
    v_mfma_f32_16x16x32_bf16 v[40:43], a[100:103], v[200:203], v[40:43]
    ds_read_b64_tr_b16 a[88:89], v230 offset:49664
    ds_read_b64_tr_b16 a[90:91], v230 offset:50688
    v_cvt_pk_bf16_f32 v195, v86, v87
    v_mfma_f32_16x16x32_bf16 v[44:47], a[100:103], v[216:219], v[44:47]
    s_waitcnt vmcnt(5)
    v_mfma_f32_16x16x32_bf16 v[44:47], a[96:99], v[212:215], v[44:47]
    s_waitcnt lgkmcnt(6)
    ds_read_b64_tr_b16 a[92:93], v230 offset:51712
    ds_read_b64_tr_b16 a[94:95], v230 offset:52736
    v_mfma_f32_16x16x32_bf16 v[0:3], a[56:59], v[220:223], v[0:3]
    buffer_load_dwordx4 v245, s[20:23], s31 offen offset:3072 nt lds
    v_mfma_f32_16x16x32_bf16 v[0:3], a[60:63], v[224:227], v[0:3]
    ds_read_b64_tr_b16 a[108:109], v231 offset:51712
    ds_read_b64_tr_b16 a[110:111], v231 offset:52736
    v_mfma_f32_16x16x32_bf16 v[4:7], a[60:63], v[208:211], v[4:7]
    v_mfma_f32_16x16x32_bf16 v[4:7], a[56:59], v[204:207], v[4:7]
    ds_read_b64_tr_b16 a[104:105], v231 offset:49664
    ds_read_b64_tr_b16 a[106:107], v231 offset:50688
    v_mfma_f32_16x16x32_bf16 v[8:11], a[56:59], v[188:191], v[8:11]
    v_mfma_f32_16x16x32_bf16 v[8:11], a[60:63], v[192:195], v[8:11]
    s_waitcnt lgkmcnt(8)
    v_mfma_f32_16x16x32_bf16 v[12:15], a[76:79], v[192:195], v[12:15]
    v_mfma_f32_16x16x32_bf16 v[12:15], a[72:75], v[188:191], v[12:15]
    v_mfma_f32_16x16x32_bf16 v[16:19], a[72:75], v[204:207], v[16:19]
    v_mfma_f32_16x16x32_bf16 v[16:19], a[76:79], v[208:211], v[16:19]
    v_mfma_f32_16x16x32_bf16 v[20:23], a[76:79], v[224:227], v[20:23]
    v_mfma_f32_16x16x32_bf16 v[20:23], a[72:75], v[220:223], v[20:23]
    v_smfmac_f32_16x16x64_bf16 v[104:107], a[252:255], v[212:219], v246
    s_waitcnt lgkmcnt(0)
    v_smfmac_f32_16x16x64_bf16 v[96:99], a[252:255], v[188:195], v246
    s_waitcnt vmcnt(12)
    v_smfmac_f32_16x16x64_bf16 v[100:103], a[252:255], v[204:211], v246
    s_barrier
    v_smfmac_f32_16x16x64_bf16 v[104:107], a[252:255], v[220:227], v246
    v_mfma_f32_16x16x32_bf16 v[24:27], a[88:91], v[220:223], v[24:27]
    ds_read_b64_tr_b16 a[112:113], v232 offset:0
    ds_read_b64_tr_b16 a[114:115], v232 offset:1024
    v_mfma_f32_16x16x32_bf16 v[24:27], a[92:95], v[224:227], v[24:27]
    s_nop 2
    v_mfma_f32_16x16x32_bf16 v[28:31], a[92:95], v[208:211], v[28:31]
    ds_read_b64_tr_b16 a[116:117], v232 offset:2048
    ds_read_b64_tr_b16 a[118:119], v232 offset:3072
    v_add_f32 v96, v96, v97
    v_mfma_f32_16x16x32_bf16 v[28:31], a[88:91], v[204:207], v[28:31]
    v_add_f32 v100, v100, v101
    v_add_f32 v104, v104, v105
    v_mfma_f32_16x16x32_bf16 v[32:35], a[88:91], v[188:191], v[32:35]
    ds_read_b64_tr_b16 a[120:121], v232 offset:512
    ds_read_b64_tr_b16 a[122:123], v232 offset:1536
    v_mfma_f32_16x16x32_bf16 v[32:35], a[92:95], v[192:195], v[32:35]
    v_rcp_f32 v98, v96
    v_mfma_f32_16x16x32_bf16 v[36:39], a[108:111], v[192:195], v[36:39]
    ds_read_b64_tr_b16 a[124:125], v232 offset:2560
    ds_read_b64_tr_b16 a[126:127], v232 offset:3584
    v_mfma_f32_16x16x32_bf16 v[36:39], a[104:107], v[188:191], v[36:39]
    v_rcp_f32 v102, v100
    v_mfma_f32_16x16x32_bf16 v[40:43], a[104:107], v[204:207], v[40:43]
L_stub2:
    s_cbranch_scc1 L_ret
    v_rcp_f32 v106, v104
    v_mfma_f32_16x16x32_bf16 v[40:43], a[108:111], v[208:211], v[40:43]
    v_max3_f32 v236, v96, v100, v104
    v_min3_f32 v237, v96, v100, v104
    v_cmp_ge_f32 vcc, 0x4b800000, v236
    v_mfma_f32_16x16x32_bf16 v[44:47], a[108:111], v[224:227], v[44:47]
    ds_read_b64_tr_b16 a[140:141], v233 offset:2560
    ds_read_b64_tr_b16 a[142:143], v233 offset:3584
    v_mfma_f32_16x16x32_bf16 v[44:47], a[104:107], v[220:223], v[44:47]
    s_waitcnt lgkmcnt(6)
    v_cndmask_b32 v237, 0, v237, vcc
    v_cmp_nle_f32 vcc, 0x33800000, v237
    v_mfma_f32_16x16x32_bf16 v[48:51], a[112:115], a[192:195], 0
    v_mfma_f32_16x16x32_bf16 v[48:51], a[116:119], a[196:199], v[48:51]
    s_waitcnt lgkmcnt(2)
    ds_read_b64_tr_b16 a[136:137], v233 offset:512
    ds_read_b64_tr_b16 a[138:139], v233 offset:1536
    v_mfma_f32_16x16x32_bf16 v[48:51], a[120:123], a[216:219], v[48:51]
    v_mul_f32 v8, v98, v8
    v_mul_f32 v9, v98, v9
    v_mfma_f32_16x16x32_bf16 v[48:51], a[124:127], a[220:223], v[48:51]
    v_mul_f32 v10, v98, v10
    v_mul_f32 v11, v98, v11
    v_mfma_f32_16x16x32_bf16 v[52:55], a[124:127], a[212:215], 0
    ds_read_b64_tr_b16 a[132:133], v233 offset:2048
    ds_read_b64_tr_b16 a[134:135], v233 offset:3072
    v_mfma_f32_16x16x32_bf16 v[52:55], a[120:123], a[208:211], v[52:55]
    v_cvt_pk_bf16_f32 v8, v8, v9
    v_cvt_pk_bf16_f32 v9, v10, v11
    v_mfma_f32_16x16x32_bf16 v[52:55], a[116:119], a[188:191], v[52:55]
    v_mul_f32 v12, v98, v12
    v_mul_f32 v13, v98, v13
    v_mfma_f32_16x16x32_bf16 v[52:55], a[112:115], a[184:187], v[52:55]
    ds_read_b64_tr_b16 a[128:129], v233 offset:0
    ds_read_b64_tr_b16 a[130:131], v233 offset:1024
    v_mfma_f32_16x16x32_bf16 v[56:59], a[112:115], a[176:179], 0
    v_mul_f32 v14, v98, v14
    v_mul_f32 v15, v98, v15
    v_mfma_f32_16x16x32_bf16 v[56:59], a[116:119], a[180:183], v[56:59]
    v_cvt_pk_bf16_f32 v12, v12, v13
    v_cvt_pk_bf16_f32 v13, v14, v15
    v_mfma_f32_16x16x32_bf16 v[56:59], a[120:123], a[200:203], v[56:59]
    ds_read_b64_tr_b16 a[144:145], v234 offset:0
    ds_read_b64_tr_b16 a[146:147], v234 offset:1024
    v_mfma_f32_16x16x32_bf16 v[56:59], a[124:127], a[204:207], v[56:59]
    s_waitcnt lgkmcnt(6)
    v_mfma_f32_16x16x32_bf16 v[60:63], a[140:143], a[204:207], 0
    ds_write_b64 v247, v[8:9] offset:0
    v_mfma_f32_16x16x32_bf16 v[60:63], a[136:139], a[200:203], v[60:63]
    s_waitcnt lgkmcnt(3)
    ds_read_b64_tr_b16 a[148:149], v234 offset:2048
    ds_read_b64_tr_b16 a[150:151], v234 offset:3072
    v_mfma_f32_16x16x32_bf16 v[60:63], a[132:135], a[180:183], v[60:63]
    v_mfma_f32_16x16x32_bf16 v[60:63], a[128:131], a[176:179], v[60:63]
    v_mfma_f32_16x16x32_bf16 v[64:67], a[128:131], a[184:187], 0
    ds_read_b64_tr_b16 a[152:153], v234 offset:512
    ds_read_b64_tr_b16 a[154:155], v234 offset:1536
    v_mfma_f32_16x16x32_bf16 v[64:67], a[132:135], a[188:191], v[64:67]
    v_mul_f32 v32, v98, v32
    v_mul_f32 v33, v98, v33
    v_mfma_f32_16x16x32_bf16 v[64:67], a[136:139], a[208:211], v[64:67]
    ds_write_b64 v248, v[12:13] offset:0
    v_mfma_f32_16x16x32_bf16 v[64:67], a[140:143], a[212:215], v[64:67]
    ds_read_b64_tr_b16 a[156:157], v234 offset:2560
    ds_read_b64_tr_b16 a[158:159], v234 offset:3584
    v_mfma_f32_16x16x32_bf16 v[68:71], a[140:143], a[220:223], 0
    v_mul_f32 v34, v98, v34
    v_mul_f32 v35, v98, v35
    v_mfma_f32_16x16x32_bf16 v[68:71], a[136:139], a[216:219], v[68:71]
    ds_read_b64_tr_b16 a[172:173], v235 offset:2560
    ds_read_b64_tr_b16 a[174:175], v235 offset:3584
    v_mfma_f32_16x16x32_bf16 v[68:71], a[132:135], a[196:199], v[68:71]
    v_cvt_pk_bf16_f32 v32, v32, v33
    v_cvt_pk_bf16_f32 v33, v34, v35
    v_mfma_f32_16x16x32_bf16 v[68:71], a[128:131], a[192:195], v[68:71]
    s_waitcnt lgkmcnt(7)
    ds_read_b64_tr_b16 a[168:169], v235 offset:512
    ds_read_b64_tr_b16 a[170:171], v235 offset:1536
    v_mfma_f32_16x16x32_bf16 v[72:75], a[144:147], a[192:195], 0
    v_mul_f32 v36, v98, v36
    v_mul_f32 v37, v98, v37
    v_mfma_f32_16x16x32_bf16 v[72:75], a[148:151], a[196:199], v[72:75]
    s_waitcnt lgkmcnt(4)
    ds_read_b64_tr_b16 a[164:165], v235 offset:2048
    ds_read_b64_tr_b16 a[166:167], v235 offset:3072
    v_mfma_f32_16x16x32_bf16 v[72:75], a[152:155], a[216:219], v[72:75]
    v_mul_f32 v38, v98, v38
    v_mul_f32 v39, v98, v39
    v_mfma_f32_16x16x32_bf16 v[72:75], a[156:159], a[220:223], v[72:75]
    ds_read_b64_tr_b16 a[160:161], v235 offset:0
    ds_read_b64_tr_b16 a[162:163], v235 offset:1024
    v_mfma_f32_16x16x32_bf16 v[76:79], a[156:159], a[212:215], 0
    v_cvt_pk_bf16_f32 v36, v36, v37
    v_cvt_pk_bf16_f32 v37, v38, v39
    v_mfma_f32_16x16x32_bf16 v[76:79], a[152:155], a[208:211], v[76:79]
    ds_write_b64 v249, v[32:33] offset:0
    v_mfma_f32_16x16x32_bf16 v[76:79], a[148:151], a[188:191], v[76:79]
    v_mfma_f32_16x16x32_bf16 v[76:79], a[144:147], a[184:187], v[76:79]
    ds_write_b64 v250, v[36:37] offset:0
    v_mfma_f32_16x16x32_bf16 v[80:83], a[144:147], a[176:179], 0
    v_mfma_f32_16x16x32_bf16 v[80:83], a[148:151], a[180:183], v[80:83]
    s_waitcnt lgkmcnt(6)
    v_mul_f32 v4, v102, v4
    v_mul_f32 v5, v102, v5
    v_mfma_f32_16x16x32_bf16 v[80:83], a[152:155], a[200:203], v[80:83]
    s_waitcnt vmcnt(8)
    v_mul_f32 v6, v102, v6
    v_mul_f32 v7, v102, v7
    v_mfma_f32_16x16x32_bf16 v[80:83], a[156:159], a[204:207], v[80:83]
    s_barrier
    v_mfma_f32_16x16x32_bf16 v[84:87], a[172:175], a[204:207], 0
    ds_read_b128 v[8:11], v251 offset:0
    ds_read_b128 v[12:15], v251 offset:1024
    v_mfma_f32_16x16x32_bf16 v[84:87], a[168:171], a[200:203], v[84:87]
    s_waitcnt lgkmcnt(4)
    ds_read_b64_tr_b16 a[48:49], v232 offset:16384
    ds_read_b64_tr_b16 a[50:51], v232 offset:17408
    v_mfma_f32_16x16x32_bf16 v[84:87], a[164:167], a[180:183], v[84:87]
    v_cvt_pk_bf16_f32 v4, v4, v5
    v_cvt_pk_bf16_f32 v5, v6, v7
    v_mfma_f32_16x16x32_bf16 v[84:87], a[160:163], a[176:179], v[84:87]
    ds_read_b64_tr_b16 a[52:53], v232 offset:18432
    ds_read_b64_tr_b16 a[54:55], v232 offset:19456
    v_mfma_f32_16x16x32_bf16 v[88:91], a[160:163], a[184:187], 0
    v_mul_f32 v16, v102, v16
    v_mul_f32 v17, v102, v17
    v_mfma_f32_16x16x32_bf16 v[88:91], a[164:167], a[188:191], v[88:91]
    ds_read_b64_tr_b16 a[56:57], v232 offset:16896
    ds_read_b64_tr_b16 a[58:59], v232 offset:17920
    v_mfma_f32_16x16x32_bf16 v[88:91], a[168:171], a[208:211], v[88:91]
    v_mul_f32 v18, v102, v18
    v_mul_f32 v19, v102, v19
    v_mfma_f32_16x16x32_bf16 v[88:91], a[172:175], a[212:215], v[88:91]
    ds_read_b64_tr_b16 a[60:61], v232 offset:18944
    ds_read_b64_tr_b16 a[62:63], v232 offset:19968
    v_mfma_f32_16x16x32_bf16 v[92:95], a[172:175], a[220:223], 0
    v_cvt_pk_bf16_f32 v16, v16, v17
    v_cvt_pk_bf16_f32 v17, v18, v19
    v_mfma_f32_16x16x32_bf16 v[92:95], a[168:171], a[216:219], v[92:95]
    ds_write_b64 v247, v[4:5] offset:2048
    v_mfma_f32_16x16x32_bf16 v[92:95], a[164:167], a[196:199], v[92:95]
    v_mul_f32 v28, v102, v28
    v_mul_f32 v29, v102, v29
    v_mfma_f32_16x16x32_bf16 v[92:95], a[160:163], a[192:195], v[92:95]
    s_waitcnt lgkmcnt(5)
    ds_read_b64_tr_b16 a[76:77], v233 offset:18944
    ds_read_b64_tr_b16 a[78:79], v233 offset:19968
    v_mfma_f32_16x16x32_bf16 v[48:51], a[48:51], a[240:243], v[48:51]
    v_mul_f32 v30, v102, v30
    v_mul_f32 v31, v102, v31
    v_mfma_f32_16x16x32_bf16 v[48:51], a[52:55], a[244:247], v[48:51]
    s_waitcnt lgkmcnt(3)
    v_cvt_pk_bf16_f32 v28, v28, v29
    v_cvt_pk_bf16_f32 v29, v30, v31
    v_mfma_f32_16x16x32_bf16 v[48:51], a[56:59], v[124:127], v[48:51]
    ds_read_b64_tr_b16 a[72:73], v233 offset:16896
    ds_read_b64_tr_b16 a[74:75], v233 offset:17920
    v_mfma_f32_16x16x32_bf16 v[48:51], a[60:63], v[128:131], v[48:51]
    v_mul_f32 v40, v102, v40
    v_mul_f32 v41, v102, v41
    v_mfma_f32_16x16x32_bf16 v[52:55], a[60:63], v[120:123], v[52:55]
    ds_write_b64 v248, v[16:17] offset:2048
    v_mfma_f32_16x16x32_bf16 v[52:55], a[56:59], v[116:119], v[52:55]
    ds_read_b64_tr_b16 a[68:69], v233 offset:18432
    ds_read_b64_tr_b16 a[70:71], v233 offset:19456
    v_mfma_f32_16x16x32_bf16 v[52:55], a[52:55], a[236:239], v[52:55]
    v_mul_f32 v42, v102, v42
    v_mul_f32 v43, v102, v43
    v_mfma_f32_16x16x32_bf16 v[52:55], a[48:51], a[232:235], v[52:55]
    ds_write_b64 v249, v[28:29] offset:2048
    v_mfma_f32_16x16x32_bf16 v[56:59], a[48:51], a[224:227], v[56:59]
    ds_read_b64_tr_b16 a[64:65], v233 offset:16384
    ds_read_b64_tr_b16 a[66:67], v233 offset:17408
    v_mfma_f32_16x16x32_bf16 v[56:59], a[52:55], a[228:231], v[56:59]
    v_cvt_pk_bf16_f32 v40, v40, v41
    v_cvt_pk_bf16_f32 v41, v42, v43
    v_mfma_f32_16x16x32_bf16 v[56:59], a[56:59], v[108:111], v[56:59]
    ds_write_b64 v250, v[40:41] offset:2048
    v_mfma_f32_16x16x32_bf16 v[56:59], a[60:63], v[112:115], v[56:59]
    s_waitcnt lgkmcnt(7)
    ds_read_b64_tr_b16 a[80:81], v234 offset:16384
    ds_read_b64_tr_b16 a[82:83], v234 offset:17408
    v_mfma_f32_16x16x32_bf16 v[60:63], a[76:79], v[112:115], v[60:63]
    v_mul_f32 v0, v106, v0
    v_mul_f32 v1, v106, v1
    v_mfma_f32_16x16x32_bf16 v[60:63], a[72:75], v[108:111], v[60:63]
    s_waitcnt lgkmcnt(3)
    v_mul_f32 v2, v106, v2
    v_mul_f32 v3, v106, v3
    v_mfma_f32_16x16x32_bf16 v[60:63], a[68:71], a[228:231], v[60:63]
    ds_read_b64_tr_b16 a[84:85], v234 offset:18432
    ds_read_b64_tr_b16 a[86:87], v234 offset:19456
    v_mfma_f32_16x16x32_bf16 v[60:63], a[64:67], a[224:227], v[60:63]
    ds_read_b128 v[4:7], v251 offset:2048
    ds_read_b128 v[16:19], v251 offset:3072
    v_mfma_f32_16x16x32_bf16 v[64:67], a[64:67], a[232:235], v[64:67]
    v_cvt_pk_bf16_f32 v0, v0, v1
    v_cvt_pk_bf16_f32 v1, v2, v3
    v_mfma_f32_16x16x32_bf16 v[64:67], a[68:71], a[236:239], v[64:67]
    ds_read_b64_tr_b16 a[88:89], v234 offset:16896
    ds_read_b64_tr_b16 a[90:91], v234 offset:17920
    v_mfma_f32_16x16x32_bf16 v[64:67], a[72:75], v[116:119], v[64:67]
    v_mul_f32 v20, v106, v20
    v_mul_f32 v21, v106, v21
    v_mfma_f32_16x16x32_bf16 v[64:67], a[76:79], v[120:123], v[64:67]
    ds_write_b64 v247, v[0:1] offset:4096
    v_mfma_f32_16x16x32_bf16 v[68:71], a[76:79], v[128:131], v[68:71]
    ds_read_b64_tr_b16 a[92:93], v234 offset:18944
    ds_read_b64_tr_b16 a[94:95], v234 offset:19968
    v_mfma_f32_16x16x32_bf16 v[68:71], a[72:75], v[124:127], v[68:71]
    v_mul_f32 v22, v106, v22
    v_mul_f32 v23, v106, v23
    v_mfma_f32_16x16x32_bf16 v[68:71], a[68:71], a[244:247], v[68:71]
    ds_read_b64_tr_b16 a[108:109], v235 offset:18944
    ds_read_b64_tr_b16 a[110:111], v235 offset:19968
    v_mfma_f32_16x16x32_bf16 v[68:71], a[64:67], a[240:243], v[68:71]
    s_waitcnt lgkmcnt(9)
    v_cvt_pk_bf16_f32 v20, v20, v21
    v_cvt_pk_bf16_f32 v21, v22, v23
    v_mfma_f32_16x16x32_bf16 v[72:75], a[80:83], a[240:243], v[72:75]
    ds_read_b64_tr_b16 a[104:105], v235 offset:16896
    ds_read_b64_tr_b16 a[106:107], v235 offset:17920
    v_mfma_f32_16x16x32_bf16 v[72:75], a[84:87], a[244:247], v[72:75]
    s_waitcnt lgkmcnt(4)
    v_mul_f32 v24, v106, v24
    v_mul_f32 v25, v106, v25
    v_mfma_f32_16x16x32_bf16 v[72:75], a[88:91], v[124:127], v[72:75]
    ds_read_b64_tr_b16 a[100:101], v235 offset:18432
    ds_read_b64_tr_b16 a[102:103], v235 offset:19456
    v_mfma_f32_16x16x32_bf16 v[72:75], a[92:95], v[128:131], v[72:75]
    v_mul_f32 v26, v106, v26
    v_mul_f32 v27, v106, v27
    v_mfma_f32_16x16x32_bf16 v[76:79], a[92:95], v[120:123], v[76:79]
    ds_read_b64_tr_b16 a[96:97], v235 offset:16384
    ds_read_b64_tr_b16 a[98:99], v235 offset:17408
    v_mfma_f32_16x16x32_bf16 v[76:79], a[88:91], v[116:119], v[76:79]
    v_cvt_pk_bf16_f32 v24, v24, v25
    v_cvt_pk_bf16_f32 v25, v26, v27
    v_mfma_f32_16x16x32_bf16 v[76:79], a[84:87], a[236:239], v[76:79]
    ds_write_b64 v248, v[20:21] offset:4096
    v_mfma_f32_16x16x32_bf16 v[76:79], a[80:83], a[232:235], v[76:79]
    v_mul_f32 v44, v106, v44
    v_mul_f32 v45, v106, v45
    v_mfma_f32_16x16x32_bf16 v[80:83], a[80:83], a[224:227], v[80:83]
    ds_write_b64 v249, v[24:25] offset:4096
    v_mfma_f32_16x16x32_bf16 v[80:83], a[84:87], a[228:231], v[80:83]
    s_waitcnt lgkmcnt(6)
    v_mul_f32 v46, v106, v46
    v_mul_f32 v47, v106, v47
    v_mfma_f32_16x16x32_bf16 v[80:83], a[88:91], v[108:111], v[80:83]
    s_waitcnt vmcnt(4)
    v_cvt_pk_bf16_f32 v44, v44, v45
    v_cvt_pk_bf16_f32 v45, v46, v47
    v_mfma_f32_16x16x32_bf16 v[80:83], a[92:95], v[112:115], v[80:83]
    s_barrier
    v_mfma_f32_16x16x32_bf16 v[84:87], a[108:111], v[112:115], v[84:87]
    ds_write_b64 v250, v[44:45] offset:4096
    v_mfma_f32_16x16x32_bf16 v[84:87], a[104:107], v[108:111], v[84:87]
    s_waitcnt lgkmcnt(3)
    ds_read_b64_tr_b16 a[112:113], v232 offset:32768
    ds_read_b64_tr_b16 a[114:115], v232 offset:33792
    v_mfma_f32_16x16x32_bf16 v[84:87], a[100:103], a[228:231], v[84:87]
    s_cbranch_vccnz L_slow
    v_mfma_f32_16x16x32_bf16 v[84:87], a[96:99], a[224:227], v[84:87]
    ds_read_b64_tr_b16 a[116:117], v232 offset:34816
    ds_read_b64_tr_b16 a[118:119], v232 offset:35840
    v_mfma_f32_16x16x32_bf16 v[88:91], a[96:99], a[232:235], v[88:91]
    buffer_store_dwordx4 v[8:11], v252, s[24:27], s56 offen offset:0 sc0 sc1 nt
    v_mfma_f32_16x16x32_bf16 v[88:91], a[100:103], a[236:239], v[88:91]
    ds_read_b64_tr_b16 a[120:121], v232 offset:33280
    ds_read_b64_tr_b16 a[122:123], v232 offset:34304
    v_mfma_f32_16x16x32_bf16 v[88:91], a[104:107], v[116:119], v[88:91]
    ds_read_b128 v[0:3], v251 offset:4096
    ds_read_b128 v[20:23], v251 offset:5120
    v_mfma_f32_16x16x32_bf16 v[88:91], a[108:111], v[120:123], v[88:91]
    ds_read_b64_tr_b16 a[124:125], v232 offset:35328
    ds_read_b64_tr_b16 a[126:127], v232 offset:36352
    v_mfma_f32_16x16x32_bf16 v[92:95], a[108:111], v[128:131], v[92:95]
    v_mfma_f32_16x16x32_bf16 v[92:95], a[104:107], v[124:127], v[92:95]
    v_mfma_f32_16x16x32_bf16 v[92:95], a[100:103], a[244:247], v[92:95]
    v_mfma_f32_16x16x32_bf16 v[92:95], a[96:99], a[240:243], v[92:95]
    s_waitcnt lgkmcnt(6)
    ds_read_b64_tr_b16 a[140:141], v233 offset:35328
    ds_read_b64_tr_b16 a[142:143], v233 offset:36352
    v_mfma_f32_16x16x32_bf16 v[48:51], a[112:115], v[148:151], v[48:51]
    buffer_store_dwordx4 v[12:15], v252, s[24:27], s56 offen offset:2048 sc0 sc1 nt
    v_mfma_f32_16x16x32_bf16 v[48:51], a[116:119], v[152:155], v[48:51]
    s_waitcnt lgkmcnt(2)
    v_mfma_f32_16x16x32_bf16 v[48:51], a[120:123], v[172:175], v[48:51]
    ds_read_b64_tr_b16 a[136:137], v233 offset:33280
    ds_read_b64_tr_b16 a[138:139], v233 offset:34304
    v_mfma_f32_16x16x32_bf16 v[48:51], a[124:127], v[176:179], v[48:51]
    v_mfma_f32_16x16x32_bf16 v[52:55], a[124:127], v[168:171], v[52:55]
    v_mfma_f32_16x16x32_bf16 v[52:55], a[120:123], v[164:167], v[52:55]
    ds_read_b64_tr_b16 a[132:133], v233 offset:34816
    ds_read_b64_tr_b16 a[134:135], v233 offset:35840
    v_mfma_f32_16x16x32_bf16 v[52:55], a[116:119], v[144:147], v[52:55]
    v_mfma_f32_16x16x32_bf16 v[52:55], a[112:115], v[140:143], v[52:55]
    buffer_store_dwordx4 v[4:7], v252, s[24:27], s57 offen offset:0 sc0 sc1 nt
    v_mfma_f32_16x16x32_bf16 v[56:59], a[112:115], v[132:135], v[56:59]
    ds_read_b64_tr_b16 a[128:129], v233 offset:32768
    ds_read_b64_tr_b16 a[130:131], v233 offset:33792
    v_mfma_f32_16x16x32_bf16 v[56:59], a[116:119], v[136:139], v[56:59]
    v_mfma_f32_16x16x32_bf16 v[56:59], a[120:123], v[156:159], v[56:59]
    v_mfma_f32_16x16x32_bf16 v[56:59], a[124:127], v[160:163], v[56:59]
    s_waitcnt lgkmcnt(4)
    ds_read_b64_tr_b16 a[144:145], v234 offset:32768
    ds_read_b64_tr_b16 a[146:147], v234 offset:33792
    v_mfma_f32_16x16x32_bf16 v[60:63], a[140:143], v[160:163], v[60:63]
    v_mfma_f32_16x16x32_bf16 v[60:63], a[136:139], v[156:159], v[60:63]
    s_waitcnt lgkmcnt(2)
    v_mfma_f32_16x16x32_bf16 v[60:63], a[132:135], v[136:139], v[60:63]
    ds_read_b64_tr_b16 a[148:149], v234 offset:34816
    ds_read_b64_tr_b16 a[150:151], v234 offset:35840
    v_mfma_f32_16x16x32_bf16 v[60:63], a[128:131], v[132:135], v[60:63]
    buffer_store_dwordx4 v[16:19], v252, s[24:27], s57 offen offset:2048 sc0 sc1 nt
    v_mfma_f32_16x16x32_bf16 v[64:67], a[128:131], v[140:143], v[64:67]
    v_mfma_f32_16x16x32_bf16 v[64:67], a[132:135], v[144:147], v[64:67]
    ds_read_b64_tr_b16 a[152:153], v234 offset:33280
    ds_read_b64_tr_b16 a[154:155], v234 offset:34304
    v_mfma_f32_16x16x32_bf16 v[64:67], a[136:139], v[164:167], v[64:67]
    v_mfma_f32_16x16x32_bf16 v[64:67], a[140:143], v[168:171], v[64:67]
    v_mfma_f32_16x16x32_bf16 v[68:71], a[140:143], v[176:179], v[68:71]
    ds_read_b64_tr_b16 a[156:157], v234 offset:35328
    ds_read_b64_tr_b16 a[158:159], v234 offset:36352
    v_mfma_f32_16x16x32_bf16 v[68:71], a[136:139], v[172:175], v[68:71]
    buffer_store_dwordx4 v[0:3], v252, s[24:27], s58 offen offset:0 sc0 sc1 nt
    v_mfma_f32_16x16x32_bf16 v[68:71], a[132:135], v[152:155], v[68:71]
    ds_read_b64_tr_b16 a[172:173], v235 offset:35328
    ds_read_b64_tr_b16 a[174:175], v235 offset:36352
    v_mfma_f32_16x16x32_bf16 v[68:71], a[128:131], v[148:151], v[68:71]
    s_waitcnt lgkmcnt(6)
    v_mfma_f32_16x16x32_bf16 v[72:75], a[144:147], v[148:151], v[72:75]
    ds_read_b64_tr_b16 a[168:169], v235 offset:33280
    ds_read_b64_tr_b16 a[170:171], v235 offset:34304
    v_mfma_f32_16x16x32_bf16 v[72:75], a[148:151], v[152:155], v[72:75]
    s_waitcnt lgkmcnt(4)
    v_mfma_f32_16x16x32_bf16 v[72:75], a[152:155], v[172:175], v[72:75]
    ds_read_b64_tr_b16 a[164:165], v235 offset:34816
    ds_read_b64_tr_b16 a[166:167], v235 offset:35840
    v_mfma_f32_16x16x32_bf16 v[72:75], a[156:159], v[176:179], v[72:75]
    v_mfma_f32_16x16x32_bf16 v[76:79], a[156:159], v[168:171], v[76:79]
    ds_read_b64_tr_b16 a[160:161], v235 offset:32768
    ds_read_b64_tr_b16 a[162:163], v235 offset:33792
    v_mfma_f32_16x16x32_bf16 v[76:79], a[152:155], v[164:167], v[76:79]
    buffer_store_dwordx4 v[20:23], v252, s[24:27], s58 offen offset:2048 sc0 sc1 nt
    v_mfma_f32_16x16x32_bf16 v[76:79], a[148:151], v[144:147], v[76:79]
    v_mfma_f32_16x16x32_bf16 v[76:79], a[144:147], v[140:143], v[76:79]
    v_mfma_f32_16x16x32_bf16 v[80:83], a[144:147], v[132:135], v[80:83]
    v_mfma_f32_16x16x32_bf16 v[80:83], a[148:151], v[136:139], v[80:83]
    v_mfma_f32_16x16x32_bf16 v[80:83], a[152:155], v[156:159], v[80:83]
    s_waitcnt lgkmcnt(0)
    v_mfma_f32_16x16x32_bf16 v[80:83], a[156:159], v[160:163], v[80:83]
    s_waitcnt vmcnt(6)
    v_mfma_f32_16x16x32_bf16 v[84:87], a[172:175], v[160:163], v[84:87]
    s_barrier
    v_mfma_f32_16x16x32_bf16 v[84:87], a[168:171], v[156:159], v[84:87]
    ds_read_b64_tr_b16 a[48:49], v232 offset:49152
    ds_read_b64_tr_b16 a[50:51], v232 offset:50176
    v_mfma_f32_16x16x32_bf16 v[84:87], a[164:167], v[136:139], v[84:87]
    ds_read_b64_tr_b16 a[52:53], v232 offset:51200
    ds_read_b64_tr_b16 a[54:55], v232 offset:52224
    v_mfma_f32_16x16x32_bf16 v[84:87], a[160:163], v[132:135], v[84:87]
    ds_read_b64_tr_b16 a[56:57], v232 offset:49664
    ds_read_b64_tr_b16 a[58:59], v232 offset:50688
    v_mfma_f32_16x16x32_bf16 v[88:91], a[160:163], v[140:143], v[88:91]
    ds_read_b64_tr_b16 a[60:61], v232 offset:51712
    ds_read_b64_tr_b16 a[62:63], v232 offset:52736
    v_mfma_f32_16x16x32_bf16 v[88:91], a[164:167], v[144:147], v[88:91]
    ds_read_b64_tr_b16 a[76:77], v233 offset:51712
    ds_read_b64_tr_b16 a[78:79], v233 offset:52736
    v_mfma_f32_16x16x32_bf16 v[88:91], a[168:171], v[164:167], v[88:91]
    ds_read_b64_tr_b16 a[72:73], v233 offset:49664
    ds_read_b64_tr_b16 a[74:75], v233 offset:50688
    v_mfma_f32_16x16x32_bf16 v[88:91], a[172:175], v[168:171], v[88:91]
    ds_read_b64_tr_b16 a[68:69], v233 offset:51200
    ds_read_b64_tr_b16 a[70:71], v233 offset:52224
    v_mfma_f32_16x16x32_bf16 v[92:95], a[172:175], v[176:179], v[92:95]
    ds_read_b64_tr_b16 a[64:65], v233 offset:49152
    ds_read_b64_tr_b16 a[66:67], v233 offset:50176
    v_mfma_f32_16x16x32_bf16 v[92:95], a[168:171], v[172:175], v[92:95]
    ds_read_b64_tr_b16 a[80:81], v234 offset:49152
    ds_read_b64_tr_b16 a[82:83], v234 offset:50176
    v_mfma_f32_16x16x32_bf16 v[92:95], a[164:167], v[152:155], v[92:95]
    ds_read_b64_tr_b16 a[84:85], v234 offset:51200
    ds_read_b64_tr_b16 a[86:87], v234 offset:52224
    v_mfma_f32_16x16x32_bf16 v[92:95], a[160:163], v[148:151], v[92:95]
    s_waitcnt lgkmcnt(15)
    ds_read_b64_tr_b16 a[88:89], v234 offset:49664
    ds_read_b64_tr_b16 a[90:91], v234 offset:50688
    v_mfma_f32_16x16x32_bf16 v[56:59], a[48:51], v[180:183], v[56:59]
    ds_read_b64_tr_b16 a[92:93], v234 offset:51712
    ds_read_b64_tr_b16 a[94:95], v234 offset:52736
    v_mfma_f32_16x16x32_bf16 v[56:59], a[52:55], v[184:187], v[56:59]
    s_waitcnt lgkmcnt(15)
    ds_read_b64_tr_b16 a[108:109], v235 offset:51712
    ds_read_b64_tr_b16 a[110:111], v235 offset:52736
    v_mfma_f32_16x16x32_bf16 v[56:59], a[56:59], v[188:191], v[56:59]
    ds_read_b64_tr_b16 a[104:105], v235 offset:49664
    ds_read_b64_tr_b16 a[106:107], v235 offset:50688
    v_mfma_f32_16x16x32_bf16 v[56:59], a[60:63], v[192:195], v[56:59]
    s_waitcnt lgkmcnt(15)
    ds_read_b64_tr_b16 a[100:101], v235 offset:51200
    ds_read_b64_tr_b16 a[102:103], v235 offset:52224
    v_mfma_f32_16x16x32_bf16 v[60:63], a[76:79], v[192:195], v[60:63]
    ds_read_b64_tr_b16 a[96:97], v235 offset:49152
    ds_read_b64_tr_b16 a[98:99], v235 offset:50176
    v_mfma_f32_16x16x32_bf16 v[60:63], a[72:75], v[188:191], v[60:63]
    s_waitcnt lgkmcnt(15)
    v_mfma_f32_16x16x32_bf16 v[60:63], a[68:71], v[184:187], v[60:63]
    v_mul_f32 v56, v98, v56
    v_mul_f32 v57, v98, v57
    v_mfma_f32_16x16x32_bf16 v[60:63], a[64:67], v[180:183], v[60:63]
    s_waitcnt lgkmcnt(12)
    v_mul_f32 v58, v98, v58
    v_mul_f32 v59, v98, v59
    v_mfma_f32_16x16x32_bf16 v[80:83], a[80:83], v[180:183], v[80:83]
    v_cvt_pk_bf16_f32 v56, v56, v57
    v_cvt_pk_bf16_f32 v57, v58, v59
    v_mfma_f32_16x16x32_bf16 v[80:83], a[84:87], v[184:187], v[80:83]
    s_waitcnt lgkmcnt(8)
    ds_write_b64 v247, v[56:57] offset:6144
    v_mfma_f32_16x16x32_bf16 v[80:83], a[88:91], v[188:191], v[80:83]
    v_mul_f32 v60, v98, v60
    v_mul_f32 v61, v98, v61
    v_mfma_f32_16x16x32_bf16 v[80:83], a[92:95], v[192:195], v[80:83]
    s_waitcnt lgkmcnt(5)
    v_mul_f32 v62, v98, v62
    v_mul_f32 v63, v98, v63
    v_mfma_f32_16x16x32_bf16 v[84:87], a[108:111], v[192:195], v[84:87]
    v_cvt_pk_bf16_f32 v60, v60, v61
    v_cvt_pk_bf16_f32 v61, v62, v63
    v_mfma_f32_16x16x32_bf16 v[84:87], a[104:107], v[188:191], v[84:87]
    s_waitcnt lgkmcnt(1)
    ds_write_b64 v248, v[60:61] offset:6144
    v_mfma_f32_16x16x32_bf16 v[84:87], a[100:103], v[184:187], v[84:87]
    v_mul_f32 v80, v98, v80
    v_mul_f32 v81, v98, v81
    v_mfma_f32_16x16x32_bf16 v[84:87], a[96:99], v[180:183], v[84:87]
    v_mul_f32 v82, v98, v82
    v_mul_f32 v83, v98, v83
    v_mfma_f32_16x16x32_bf16 v[52:55], a[48:51], v[196:199], v[52:55]
    v_cvt_pk_bf16_f32 v80, v80, v81
    v_cvt_pk_bf16_f32 v81, v82, v83
    v_mfma_f32_16x16x32_bf16 v[52:55], a[52:55], v[200:203], v[52:55]
    ds_write_b64 v249, v[80:81] offset:6144
    v_mfma_f32_16x16x32_bf16 v[52:55], a[56:59], v[204:207], v[52:55]
    v_mul_f32 v84, v98, v84
    v_mul_f32 v85, v98, v85
    v_mfma_f32_16x16x32_bf16 v[52:55], a[60:63], v[208:211], v[52:55]
    v_mul_f32 v86, v98, v86
    v_mul_f32 v87, v98, v87
    v_mfma_f32_16x16x32_bf16 v[64:67], a[76:79], v[208:211], v[64:67]
    v_cvt_pk_bf16_f32 v84, v84, v85
    v_cvt_pk_bf16_f32 v85, v86, v87
    v_mfma_f32_16x16x32_bf16 v[64:67], a[72:75], v[204:207], v[64:67]
    ds_write_b64 v250, v[84:85] offset:6144
    v_mfma_f32_16x16x32_bf16 v[64:67], a[68:71], v[200:203], v[64:67]
    v_mul_f32 v52, v102, v52
    v_mul_f32 v53, v102, v53
    v_mfma_f32_16x16x32_bf16 v[64:67], a[64:67], v[196:199], v[64:67]
    ds_read_b128 v[56:59], v251 offset:6144
    ds_read_b128 v[60:63], v251 offset:7168
    v_mul_f32 v54, v102, v54
    v_mul_f32 v55, v102, v55
    v_mfma_f32_16x16x32_bf16 v[76:79], a[80:83], v[196:199], v[76:79]
    v_cvt_pk_bf16_f32 v52, v52, v53
    v_cvt_pk_bf16_f32 v53, v54, v55
    v_mfma_f32_16x16x32_bf16 v[76:79], a[84:87], v[200:203], v[76:79]
    ds_write_b64 v247, v[52:53] offset:8192
    v_mfma_f32_16x16x32_bf16 v[76:79], a[88:91], v[204:207], v[76:79]
    v_mul_f32 v64, v102, v64
    v_mul_f32 v65, v102, v65
    v_mfma_f32_16x16x32_bf16 v[76:79], a[92:95], v[208:211], v[76:79]
    v_mul_f32 v66, v102, v66
    v_mul_f32 v67, v102, v67
    v_mfma_f32_16x16x32_bf16 v[88:91], a[108:111], v[208:211], v[88:91]
    v_cvt_pk_bf16_f32 v64, v64, v65
    v_cvt_pk_bf16_f32 v65, v66, v67
    v_mfma_f32_16x16x32_bf16 v[88:91], a[104:107], v[204:207], v[88:91]
    s_waitcnt lgkmcnt(1)
    ds_write_b64 v248, v[64:65] offset:8192
    v_mfma_f32_16x16x32_bf16 v[88:91], a[100:103], v[200:203], v[88:91]
    buffer_store_dwordx4 v[56:59], v252, s[24:27], s59 offen offset:0 sc0 sc1 nt
    v_mul_f32 v76, v102, v76
    v_mul_f32 v77, v102, v77
    v_mfma_f32_16x16x32_bf16 v[88:91], a[96:99], v[196:199], v[88:91]
    v_mul_f32 v78, v102, v78
    v_mul_f32 v79, v102, v79
    v_mfma_f32_16x16x32_bf16 v[48:51], a[48:51], v[212:215], v[48:51]
    v_cvt_pk_bf16_f32 v76, v76, v77
    v_cvt_pk_bf16_f32 v77, v78, v79
    v_mfma_f32_16x16x32_bf16 v[48:51], a[52:55], v[216:219], v[48:51]
    ds_write_b64 v249, v[76:77] offset:8192
    v_mfma_f32_16x16x32_bf16 v[48:51], a[56:59], v[220:223], v[48:51]
    buffer_store_dwordx4 v[60:63], v252, s[24:27], s59 offen offset:2048 sc0 sc1 nt
    v_mul_f32 v88, v102, v88
    v_mul_f32 v89, v102, v89
    v_mfma_f32_16x16x32_bf16 v[48:51], a[60:63], v[224:227], v[48:51]
    v_mul_f32 v90, v102, v90
    v_mul_f32 v91, v102, v91
    v_mfma_f32_16x16x32_bf16 v[68:71], a[76:79], v[224:227], v[68:71]
    v_cvt_pk_bf16_f32 v88, v88, v89
    v_cvt_pk_bf16_f32 v89, v90, v91
    v_mfma_f32_16x16x32_bf16 v[68:71], a[72:75], v[220:223], v[68:71]
    ds_write_b64 v250, v[88:89] offset:8192
    v_mfma_f32_16x16x32_bf16 v[68:71], a[68:71], v[216:219], v[68:71]
    v_mul_f32 v48, v106, v48
    v_mul_f32 v49, v106, v49
    v_mfma_f32_16x16x32_bf16 v[68:71], a[64:67], v[212:215], v[68:71]
    ds_read_b128 v[52:55], v251 offset:8192
    ds_read_b128 v[64:67], v251 offset:9216
    v_mul_f32 v50, v106, v50
    v_mul_f32 v51, v106, v51
    v_mfma_f32_16x16x32_bf16 v[72:75], a[80:83], v[212:215], v[72:75]
    v_cvt_pk_bf16_f32 v48, v48, v49
    v_cvt_pk_bf16_f32 v49, v50, v51
    v_mfma_f32_16x16x32_bf16 v[72:75], a[84:87], v[216:219], v[72:75]
    ds_write_b64 v247, v[48:49] offset:10240
    v_mfma_f32_16x16x32_bf16 v[72:75], a[88:91], v[220:223], v[72:75]
    v_mul_f32 v68, v106, v68
    v_mul_f32 v69, v106, v69
    v_mfma_f32_16x16x32_bf16 v[72:75], a[92:95], v[224:227], v[72:75]
    v_mul_f32 v70, v106, v70
    v_mul_f32 v71, v106, v71
    v_mfma_f32_16x16x32_bf16 v[92:95], a[108:111], v[224:227], v[92:95]
    v_cvt_pk_bf16_f32 v68, v68, v69
    v_cvt_pk_bf16_f32 v69, v70, v71
    v_mfma_f32_16x16x32_bf16 v[92:95], a[104:107], v[220:223], v[92:95]
    s_waitcnt lgkmcnt(1)
    ds_write_b64 v248, v[68:69] offset:10240
    v_mfma_f32_16x16x32_bf16 v[92:95], a[100:103], v[216:219], v[92:95]
    buffer_store_dwordx4 v[52:55], v252, s[24:27], s60 offen offset:0 sc0 sc1 nt
    v_mul_f32 v72, v106, v72
    v_mul_f32 v73, v106, v73
    v_mfma_f32_16x16x32_bf16 v[92:95], a[96:99], v[212:215], v[92:95]
    v_mul_f32 v74, v106, v74
    v_mul_f32 v75, v106, v75
    v_cvt_pk_bf16_f32 v72, v72, v73
    v_cvt_pk_bf16_f32 v73, v74, v75
    ds_write_b64 v249, v[72:73] offset:10240
    buffer_store_dwordx4 v[64:67], v252, s[24:27], s60 offen offset:2048 sc0 sc1 nt
    s_nop 1
    v_pk_mul_f32 v[92:93], v[92:93], v[106:107] op_sel_hi:[1,0]
    v_pk_mul_f32 v[94:95], v[94:95], v[106:107] op_sel_hi:[1,0]
    v_cvt_pk_bf16_f32 v92, v92, v93
    v_cvt_pk_bf16_f32 v93, v94, v95
    ds_write_b64 v250, v[92:93] offset:10240
    ds_read_b128 v[48:51], v251 offset:10240
    ds_read_b128 v[68:71], v251 offset:11264
    s_waitcnt lgkmcnt(1)
    buffer_store_dwordx4 v[48:51], v252, s[24:27], s61 offen offset:0 sc0 sc1 nt
    s_waitcnt lgkmcnt(0)
    buffer_store_dwordx4 v[68:71], v252, s[24:27], s61 offen offset:2048 sc0 sc1 nt
L_fastend:
L_end:
    s_endpgm
L_codeend:
L_slow:
    s_waitcnt vmcnt(0) lgkmcnt(0)
    s_barrier
    s_nop 15
    s_nop 15
    v_mbcnt_lo_u32_b32 v220, -1, 0
    v_mbcnt_hi_u32_b32 v220, -1, v220
    s_lshl_b32 s47, s34, 12
    s_sub_u32 s44, s29, s47
    s_lshl_b32 s45, s34, 14
    v_lshrrev_b32 v221, 4, v220
    v_and_b32 v222, 15, v220
    v_xor_b32 v223, v221, v222
    v_lshlrev_b32 v223, 4, v223
    v_lshl_add_u32 v204, v221, 8, v223
    v_xor_b32 v205, 64, v204
    v_xor_b32 v206, 128, v204
    v_xor_b32 v207, 192, v204
    v_lshlrev_b32 v224, 1, v221
    v_xor_b32 v224, v224, v222
    v_lshlrev_b32 v224, 4, v224
    v_lshl_add_u32 v208, v221, 8, v224
    v_xor_b32 v209, 0x80, v208
    v_lshrrev_b32 v225, 2, v222
    v_and_b32 v226, 3, v222
    v_lshl_add_u32 v224, v225, 4, v226
    v_lshl_add_u32 v192, v224, 8, v223
    v_add_u32 v192, s45, v192
    v_xor_b32 v193, 64, v192
    v_xor_b32 v194, 128, v192
    v_xor_b32 v195, 192, v192
    v_lshl_add_u32 v224, v221, 4, v225
    v_lshlrev_b32 v224, 8, v224
    v_and_b32 v196, 1, v221
    v_lshl_add_u32 v196, v196, 2, v225
    v_lshl_add_u32 v224, v196, 5, v224
    v_lshl_add_u32 v196, v226, 3, v224
    v_add_u32 v196, s45, v196
    v_xor_b32 v197, 32, v196
    v_xor_b32 v198, 64, v196
    v_xor_b32 v199, 96, v196
    v_xor_b32 v200, 128, v196
    v_xor_b32 v201, 160, v196
    v_xor_b32 v202, 192, v196
    v_xor_b32 v203, 224, v196
    v_lshrrev_b32 v223, 1, v221
    v_and_b32 v224, 7, v222
    v_xor_b32 v223, v223, v224
    v_lshlrev_b32 v223, 4, v223
    v_lshl_add_u32 v223, v222, 7, v223
    v_and_b32 v224, 1, v221
    v_lshl_add_u32 v223, v224, 3, v223
    v_add_u32 v210, s45, v223
    v_xor_b32 v211, 32, v210
    v_xor_b32 v212, 64, v210
    v_xor_b32 v213, 96, v210
    v_lshrrev_b32 v223, 3, v220
    v_and_b32 v224, 7, v220
    v_lshlrev_b32 v215, 4, v224
    v_lshl_add_u32 v215, v223, 8, v215
    v_xor_b32 v224, v224, v223
    v_lshlrev_b32 v224, 4, v224
    v_lshl_add_u32 v224, v223, 7, v224
    v_add_u32 v214, s45, v224
    v_lshlrev_b32 v224, 4, v221
    v_lshl_add_u32 v224, v222, 8, v224
    s_add_u32 s47, s28, 0
    buffer_load_dwordx4 a[0:3], v224, s[12:15], s47 offen offset:0
    buffer_load_dwordx4 a[4:7], v224, s[12:15], s47 offen offset:64
    buffer_load_dwordx4 a[8:11], v224, s[12:15], s47 offen offset:128
    buffer_load_dwordx4 a[12:15], v224, s[12:15], s47 offen offset:192
    s_add_u32 s47, s28, 16384
    buffer_load_dwordx4 a[16:19], v224, s[12:15], s47 offen offset:0
    buffer_load_dwordx4 a[20:23], v224, s[12:15], s47 offen offset:64
    buffer_load_dwordx4 a[24:27], v224, s[12:15], s47 offen offset:128
    buffer_load_dwordx4 a[28:31], v224, s[12:15], s47 offen offset:192
    s_add_u32 s47, s28, 32768
    buffer_load_dwordx4 a[32:35], v224, s[12:15], s47 offen offset:0
    buffer_load_dwordx4 a[36:39], v224, s[12:15], s47 offen offset:64
    buffer_load_dwordx4 a[40:43], v224, s[12:15], s47 offen offset:128
    buffer_load_dwordx4 a[44:47], v224, s[12:15], s47 offen offset:192
    s_waitcnt vmcnt(0)
    v_mov_b32 v216, 0xff800000
    v_mov_b32 v217, 0xff800000
    v_mov_b32 v218, 0xff800000
    s_mov_b32 s46, s44
L_slow1:
    s_add_u32 m0, s45, 0
    s_add_u32 s47, s46, 0
    buffer_load_dwordx4 v204, s[16:19], s47 offen offset:0 lds
    buffer_load_dwordx4 v204, s[16:19], s47 offen offset:1024 lds
    buffer_load_dwordx4 v204, s[16:19], s47 offen offset:2048 lds
    buffer_load_dwordx4 v204, s[16:19], s47 offen offset:3072 lds
    s_add_u32 m0, s45, 4096
    s_add_u32 s47, s46, 4096
    buffer_load_dwordx4 v205, s[16:19], s47 offen offset:0 lds
    buffer_load_dwordx4 v205, s[16:19], s47 offen offset:1024 lds
    buffer_load_dwordx4 v205, s[16:19], s47 offen offset:2048 lds
    buffer_load_dwordx4 v205, s[16:19], s47 offen offset:3072 lds
    s_add_u32 m0, s45, 8192
    s_add_u32 s47, s46, 8192
    buffer_load_dwordx4 v206, s[16:19], s47 offen offset:0 lds
    buffer_load_dwordx4 v206, s[16:19], s47 offen offset:1024 lds
    buffer_load_dwordx4 v206, s[16:19], s47 offen offset:2048 lds
    buffer_load_dwordx4 v206, s[16:19], s47 offen offset:3072 lds
    s_add_u32 m0, s45, 12288
    s_add_u32 s47, s46, 12288
    buffer_load_dwordx4 v207, s[16:19], s47 offen offset:0 lds
    buffer_load_dwordx4 v207, s[16:19], s47 offen offset:1024 lds
    buffer_load_dwordx4 v207, s[16:19], s47 offen offset:2048 lds
    buffer_load_dwordx4 v207, s[16:19], s47 offen offset:3072 lds
    s_waitcnt vmcnt(0)
    ds_read_b128 a[48:51], v192 offset:0
    ds_read_b128 a[52:55], v193 offset:0
    ds_read_b128 a[56:59], v194 offset:0
    ds_read_b128 a[60:63], v195 offset:0
    ds_read_b128 a[64:67], v192 offset:1024
    ds_read_b128 a[68:71], v193 offset:1024
    ds_read_b128 a[72:75], v194 offset:1024
    ds_read_b128 a[76:79], v195 offset:1024
    ds_read_b128 a[80:83], v192 offset:2048
    ds_read_b128 a[84:87], v193 offset:2048
    ds_read_b128 a[88:91], v194 offset:2048
    ds_read_b128 a[92:95], v195 offset:2048
    ds_read_b128 a[96:99], v192 offset:3072
    ds_read_b128 a[100:103], v193 offset:3072
    ds_read_b128 a[104:107], v194 offset:3072
    ds_read_b128 a[108:111], v195 offset:3072
    s_waitcnt lgkmcnt(0)
    v_mfma_f32_16x16x32_bf16 v[108:111], a[48:51], a[0:3], 0
    v_mfma_f32_16x16x32_bf16 v[108:111], a[52:55], a[4:7], v[108:111]
    v_mfma_f32_16x16x32_bf16 v[108:111], a[56:59], a[8:11], v[108:111]
    v_mfma_f32_16x16x32_bf16 v[108:111], a[60:63], a[12:15], v[108:111]
    v_mfma_f32_16x16x32_bf16 v[112:115], a[48:51], a[16:19], 0
    v_mfma_f32_16x16x32_bf16 v[112:115], a[52:55], a[20:23], v[112:115]
    v_mfma_f32_16x16x32_bf16 v[112:115], a[56:59], a[24:27], v[112:115]
    v_mfma_f32_16x16x32_bf16 v[112:115], a[60:63], a[28:31], v[112:115]
    v_mfma_f32_16x16x32_bf16 v[116:119], a[48:51], a[32:35], 0
    v_mfma_f32_16x16x32_bf16 v[116:119], a[52:55], a[36:39], v[116:119]
    v_mfma_f32_16x16x32_bf16 v[116:119], a[56:59], a[40:43], v[116:119]
    v_mfma_f32_16x16x32_bf16 v[116:119], a[60:63], a[44:47], v[116:119]
    v_mfma_f32_16x16x32_bf16 v[120:123], a[64:67], a[0:3], 0
    v_mfma_f32_16x16x32_bf16 v[120:123], a[68:71], a[4:7], v[120:123]
    v_mfma_f32_16x16x32_bf16 v[120:123], a[72:75], a[8:11], v[120:123]
    v_mfma_f32_16x16x32_bf16 v[120:123], a[76:79], a[12:15], v[120:123]
    v_mfma_f32_16x16x32_bf16 v[124:127], a[64:67], a[16:19], 0
    v_mfma_f32_16x16x32_bf16 v[124:127], a[68:71], a[20:23], v[124:127]
    v_mfma_f32_16x16x32_bf16 v[124:127], a[72:75], a[24:27], v[124:127]
    v_mfma_f32_16x16x32_bf16 v[124:127], a[76:79], a[28:31], v[124:127]
    v_mfma_f32_16x16x32_bf16 v[128:131], a[64:67], a[32:35], 0
    v_mfma_f32_16x16x32_bf16 v[128:131], a[68:71], a[36:39], v[128:131]
    v_mfma_f32_16x16x32_bf16 v[128:131], a[72:75], a[40:43], v[128:131]
    v_mfma_f32_16x16x32_bf16 v[128:131], a[76:79], a[44:47], v[128:131]
    v_mfma_f32_16x16x32_bf16 v[132:135], a[80:83], a[0:3], 0
    v_mfma_f32_16x16x32_bf16 v[132:135], a[84:87], a[4:7], v[132:135]
    v_mfma_f32_16x16x32_bf16 v[132:135], a[88:91], a[8:11], v[132:135]
    v_mfma_f32_16x16x32_bf16 v[132:135], a[92:95], a[12:15], v[132:135]
    v_mfma_f32_16x16x32_bf16 v[136:139], a[80:83], a[16:19], 0
    v_mfma_f32_16x16x32_bf16 v[136:139], a[84:87], a[20:23], v[136:139]
    v_mfma_f32_16x16x32_bf16 v[136:139], a[88:91], a[24:27], v[136:139]
    v_mfma_f32_16x16x32_bf16 v[136:139], a[92:95], a[28:31], v[136:139]
    v_mfma_f32_16x16x32_bf16 v[140:143], a[80:83], a[32:35], 0
    v_mfma_f32_16x16x32_bf16 v[140:143], a[84:87], a[36:39], v[140:143]
    v_mfma_f32_16x16x32_bf16 v[140:143], a[88:91], a[40:43], v[140:143]
    v_mfma_f32_16x16x32_bf16 v[140:143], a[92:95], a[44:47], v[140:143]
    v_mfma_f32_16x16x32_bf16 v[144:147], a[96:99], a[0:3], 0
    v_mfma_f32_16x16x32_bf16 v[144:147], a[100:103], a[4:7], v[144:147]
    v_mfma_f32_16x16x32_bf16 v[144:147], a[104:107], a[8:11], v[144:147]
    v_mfma_f32_16x16x32_bf16 v[144:147], a[108:111], a[12:15], v[144:147]
    v_mfma_f32_16x16x32_bf16 v[148:151], a[96:99], a[16:19], 0
    v_mfma_f32_16x16x32_bf16 v[148:151], a[100:103], a[20:23], v[148:151]
    v_mfma_f32_16x16x32_bf16 v[148:151], a[104:107], a[24:27], v[148:151]
    v_mfma_f32_16x16x32_bf16 v[148:151], a[108:111], a[28:31], v[148:151]
    v_mfma_f32_16x16x32_bf16 v[152:155], a[96:99], a[32:35], 0
    v_mfma_f32_16x16x32_bf16 v[152:155], a[100:103], a[36:39], v[152:155]
    v_mfma_f32_16x16x32_bf16 v[152:155], a[104:107], a[40:43], v[152:155]
    v_mfma_f32_16x16x32_bf16 v[152:155], a[108:111], a[44:47], v[152:155]
    v_max3_f32 v216, v216, v108, v109
    v_max3_f32 v216, v216, v110, v111
    v_max3_f32 v217, v217, v112, v113
    v_max3_f32 v217, v217, v114, v115
    v_max3_f32 v218, v218, v116, v117
    v_max3_f32 v218, v218, v118, v119
    v_max3_f32 v216, v216, v120, v121
    v_max3_f32 v216, v216, v122, v123
    v_max3_f32 v217, v217, v124, v125
    v_max3_f32 v217, v217, v126, v127
    v_max3_f32 v218, v218, v128, v129
    v_max3_f32 v218, v218, v130, v131
    v_max3_f32 v216, v216, v132, v133
    v_max3_f32 v216, v216, v134, v135
    v_max3_f32 v217, v217, v136, v137
    v_max3_f32 v217, v217, v138, v139
    v_max3_f32 v218, v218, v140, v141
    v_max3_f32 v218, v218, v142, v143
    v_max3_f32 v216, v216, v144, v145
    v_max3_f32 v216, v216, v146, v147
    v_max3_f32 v217, v217, v148, v149
    v_max3_f32 v217, v217, v150, v151
    v_max3_f32 v218, v218, v152, v153
    v_max3_f32 v218, v218, v154, v155
    s_add_u32 s46, s46, 16384
    s_sub_u32 s47, s46, s44
    s_cmp_lt_u32 s47, 131072
    s_nop 15
    s_cbranch_scc1 L_slow1
    v_mov_b32 v223, v216
    s_nop 1
    v_permlane32_swap_b32 v223, v216
    v_max_f32 v216, v216, v223
    v_mov_b32 v223, v216
    s_nop 1
    v_permlane16_swap_b32 v223, v216
    v_max_f32 v216, v216, v223
    v_mov_b32 v223, v217
    s_nop 1
    v_permlane32_swap_b32 v223, v217
    v_max_f32 v217, v217, v223
    v_mov_b32 v223, v217
    s_nop 1
    v_permlane16_swap_b32 v223, v217
    v_max_f32 v217, v217, v223
    v_mov_b32 v223, v218
    s_nop 1
    v_permlane32_swap_b32 v223, v218
    v_max_f32 v218, v218, v223
    v_mov_b32 v223, v218
    s_nop 1
    v_permlane16_swap_b32 v223, v218
    v_max_f32 v218, v218, v223
    v_mov_b32 v0, 0
    v_mov_b32 v1, 0
    v_mov_b32 v2, 0
    v_mov_b32 v3, 0
    v_mov_b32 v4, 0
    v_mov_b32 v5, 0
    v_mov_b32 v6, 0
    v_mov_b32 v7, 0
    v_mov_b32 v8, 0
    v_mov_b32 v9, 0
    v_mov_b32 v10, 0
    v_mov_b32 v11, 0
    v_mov_b32 v12, 0
    v_mov_b32 v13, 0
    v_mov_b32 v14, 0
    v_mov_b32 v15, 0
    v_mov_b32 v16, 0
    v_mov_b32 v17, 0
    v_mov_b32 v18, 0
    v_mov_b32 v19, 0
    v_mov_b32 v20, 0
    v_mov_b32 v21, 0
    v_mov_b32 v22, 0
    v_mov_b32 v23, 0
    v_mov_b32 v24, 0
    v_mov_b32 v25, 0
    v_mov_b32 v26, 0
    v_mov_b32 v27, 0
    v_mov_b32 v28, 0
    v_mov_b32 v29, 0
    v_mov_b32 v30, 0
    v_mov_b32 v31, 0
    v_mov_b32 v32, 0
    v_mov_b32 v33, 0
    v_mov_b32 v34, 0
    v_mov_b32 v35, 0
    v_mov_b32 v36, 0
    v_mov_b32 v37, 0
    v_mov_b32 v38, 0
    v_mov_b32 v39, 0
    v_mov_b32 v40, 0
    v_mov_b32 v41, 0
    v_mov_b32 v42, 0
    v_mov_b32 v43, 0
    v_mov_b32 v44, 0
    v_mov_b32 v45, 0
    v_mov_b32 v46, 0
    v_mov_b32 v47, 0
    v_mov_b32 v48, 0
    v_mov_b32 v49, 0
    v_mov_b32 v50, 0
    v_mov_b32 v51, 0
    v_mov_b32 v52, 0
    v_mov_b32 v53, 0
    v_mov_b32 v54, 0
    v_mov_b32 v55, 0
    v_mov_b32 v56, 0
    v_mov_b32 v57, 0
    v_mov_b32 v58, 0
    v_mov_b32 v59, 0
    v_mov_b32 v60, 0
    v_mov_b32 v61, 0
    v_mov_b32 v62, 0
    v_mov_b32 v63, 0
    v_mov_b32 v64, 0
    v_mov_b32 v65, 0
    v_mov_b32 v66, 0
    v_mov_b32 v67, 0
    v_mov_b32 v68, 0
    v_mov_b32 v69, 0
    v_mov_b32 v70, 0
    v_mov_b32 v71, 0
    v_mov_b32 v72, 0
    v_mov_b32 v73, 0
    v_mov_b32 v74, 0
    v_mov_b32 v75, 0
    v_mov_b32 v76, 0
    v_mov_b32 v77, 0
    v_mov_b32 v78, 0
    v_mov_b32 v79, 0
    v_mov_b32 v80, 0
    v_mov_b32 v81, 0
    v_mov_b32 v82, 0
    v_mov_b32 v83, 0
    v_mov_b32 v84, 0
    v_mov_b32 v85, 0
    v_mov_b32 v86, 0
    v_mov_b32 v87, 0
    v_mov_b32 v88, 0
    v_mov_b32 v89, 0
    v_mov_b32 v90, 0
    v_mov_b32 v91, 0
    v_mov_b32 v92, 0
    v_mov_b32 v93, 0
    v_mov_b32 v94, 0
    v_mov_b32 v95, 0
    v_mov_b32 v96, 0
    v_mov_b32 v97, 0
    v_mov_b32 v98, 0
    v_mov_b32 v99, 0
    v_mov_b32 v100, 0
    v_mov_b32 v101, 0
    v_mov_b32 v102, 0
    v_mov_b32 v103, 0
    v_mov_b32 v104, 0
    v_mov_b32 v105, 0
    v_mov_b32 v106, 0
    v_mov_b32 v107, 0
    s_mov_b32 s46, s44
    s_nop 7
L_slow2:
    s_add_u32 m0, s45, 0
    s_add_u32 s47, s46, 0
    buffer_load_dwordx4 v204, s[16:19], s47 offen offset:0 lds
    buffer_load_dwordx4 v204, s[16:19], s47 offen offset:1024 lds
    buffer_load_dwordx4 v204, s[16:19], s47 offen offset:2048 lds
    buffer_load_dwordx4 v204, s[16:19], s47 offen offset:3072 lds
    s_add_u32 m0, s45, 4096
    s_add_u32 s47, s46, 4096
    buffer_load_dwordx4 v205, s[16:19], s47 offen offset:0 lds
    buffer_load_dwordx4 v205, s[16:19], s47 offen offset:1024 lds
    buffer_load_dwordx4 v205, s[16:19], s47 offen offset:2048 lds
    buffer_load_dwordx4 v205, s[16:19], s47 offen offset:3072 lds
    s_add_u32 m0, s45, 8192
    s_add_u32 s47, s46, 8192
    buffer_load_dwordx4 v206, s[16:19], s47 offen offset:0 lds
    buffer_load_dwordx4 v206, s[16:19], s47 offen offset:1024 lds
    buffer_load_dwordx4 v206, s[16:19], s47 offen offset:2048 lds
    buffer_load_dwordx4 v206, s[16:19], s47 offen offset:3072 lds
    s_add_u32 m0, s45, 12288
    s_add_u32 s47, s46, 12288
    buffer_load_dwordx4 v207, s[16:19], s47 offen offset:0 lds
    buffer_load_dwordx4 v207, s[16:19], s47 offen offset:1024 lds
    buffer_load_dwordx4 v207, s[16:19], s47 offen offset:2048 lds
    buffer_load_dwordx4 v207, s[16:19], s47 offen offset:3072 lds
    s_waitcnt vmcnt(0)
    ds_read_b128 a[48:51], v192 offset:0
    ds_read_b128 a[52:55], v193 offset:0
    ds_read_b128 a[56:59], v194 offset:0
    ds_read_b128 a[60:63], v195 offset:0
    ds_read_b128 a[64:67], v192 offset:1024
    ds_read_b128 a[68:71], v193 offset:1024
    ds_read_b128 a[72:75], v194 offset:1024
    ds_read_b128 a[76:79], v195 offset:1024
    ds_read_b128 a[80:83], v192 offset:2048
    ds_read_b128 a[84:87], v193 offset:2048
    ds_read_b128 a[88:91], v194 offset:2048
    ds_read_b128 a[92:95], v195 offset:2048
    ds_read_b128 a[96:99], v192 offset:3072
    ds_read_b128 a[100:103], v193 offset:3072
    ds_read_b128 a[104:107], v194 offset:3072
    ds_read_b128 a[108:111], v195 offset:3072
    s_waitcnt lgkmcnt(0)
    s_add_u32 m0, s45, 0
    s_add_u32 s47, s46, 0
    buffer_load_dwordx4 v208, s[20:23], s47 offen offset:0 lds
    buffer_load_dwordx4 v208, s[20:23], s47 offen offset:1024 lds
    buffer_load_dwordx4 v208, s[20:23], s47 offen offset:2048 lds
    buffer_load_dwordx4 v208, s[20:23], s47 offen offset:3072 lds
    s_add_u32 m0, s45, 4096
    s_add_u32 s47, s46, 4096
    buffer_load_dwordx4 v209, s[20:23], s47 offen offset:0 lds
    buffer_load_dwordx4 v209, s[20:23], s47 offen offset:1024 lds
    buffer_load_dwordx4 v209, s[20:23], s47 offen offset:2048 lds
    buffer_load_dwordx4 v209, s[20:23], s47 offen offset:3072 lds
    s_add_u32 m0, s45, 8192
    s_add_u32 s47, s46, 8192
    buffer_load_dwordx4 v208, s[20:23], s47 offen offset:0 lds
    buffer_load_dwordx4 v208, s[20:23], s47 offen offset:1024 lds
    buffer_load_dwordx4 v208, s[20:23], s47 offen offset:2048 lds
    buffer_load_dwordx4 v208, s[20:23], s47 offen offset:3072 lds
    s_add_u32 m0, s45, 12288
    s_add_u32 s47, s46, 12288
    buffer_load_dwordx4 v209, s[20:23], s47 offen offset:0 lds
    buffer_load_dwordx4 v209, s[20:23], s47 offen offset:1024 lds
    buffer_load_dwordx4 v209, s[20:23], s47 offen offset:2048 lds
    buffer_load_dwordx4 v209, s[20:23], s47 offen offset:3072 lds
    v_mfma_f32_16x16x32_bf16 v[108:111], a[48:51], a[0:3], 0
    v_mfma_f32_16x16x32_bf16 v[108:111], a[52:55], a[4:7], v[108:111]
    v_mfma_f32_16x16x32_bf16 v[108:111], a[56:59], a[8:11], v[108:111]
    v_mfma_f32_16x16x32_bf16 v[108:111], a[60:63], a[12:15], v[108:111]
    v_mfma_f32_16x16x32_bf16 v[112:115], a[48:51], a[16:19], 0
    v_mfma_f32_16x16x32_bf16 v[112:115], a[52:55], a[20:23], v[112:115]
    v_mfma_f32_16x16x32_bf16 v[112:115], a[56:59], a[24:27], v[112:115]
    v_mfma_f32_16x16x32_bf16 v[112:115], a[60:63], a[28:31], v[112:115]
    v_mfma_f32_16x16x32_bf16 v[116:119], a[48:51], a[32:35], 0
    v_mfma_f32_16x16x32_bf16 v[116:119], a[52:55], a[36:39], v[116:119]
    v_mfma_f32_16x16x32_bf16 v[116:119], a[56:59], a[40:43], v[116:119]
    v_mfma_f32_16x16x32_bf16 v[116:119], a[60:63], a[44:47], v[116:119]
    v_mfma_f32_16x16x32_bf16 v[120:123], a[64:67], a[0:3], 0
    v_mfma_f32_16x16x32_bf16 v[120:123], a[68:71], a[4:7], v[120:123]
    v_mfma_f32_16x16x32_bf16 v[120:123], a[72:75], a[8:11], v[120:123]
    v_mfma_f32_16x16x32_bf16 v[120:123], a[76:79], a[12:15], v[120:123]
    v_mfma_f32_16x16x32_bf16 v[124:127], a[64:67], a[16:19], 0
    v_mfma_f32_16x16x32_bf16 v[124:127], a[68:71], a[20:23], v[124:127]
    v_mfma_f32_16x16x32_bf16 v[124:127], a[72:75], a[24:27], v[124:127]
    v_mfma_f32_16x16x32_bf16 v[124:127], a[76:79], a[28:31], v[124:127]
    v_mfma_f32_16x16x32_bf16 v[128:131], a[64:67], a[32:35], 0
    v_mfma_f32_16x16x32_bf16 v[128:131], a[68:71], a[36:39], v[128:131]
    v_mfma_f32_16x16x32_bf16 v[128:131], a[72:75], a[40:43], v[128:131]
    v_mfma_f32_16x16x32_bf16 v[128:131], a[76:79], a[44:47], v[128:131]
    v_mfma_f32_16x16x32_bf16 v[132:135], a[80:83], a[0:3], 0
    v_mfma_f32_16x16x32_bf16 v[132:135], a[84:87], a[4:7], v[132:135]
    v_mfma_f32_16x16x32_bf16 v[132:135], a[88:91], a[8:11], v[132:135]
    v_mfma_f32_16x16x32_bf16 v[132:135], a[92:95], a[12:15], v[132:135]
    v_mfma_f32_16x16x32_bf16 v[136:139], a[80:83], a[16:19], 0
    v_mfma_f32_16x16x32_bf16 v[136:139], a[84:87], a[20:23], v[136:139]
    v_mfma_f32_16x16x32_bf16 v[136:139], a[88:91], a[24:27], v[136:139]
    v_mfma_f32_16x16x32_bf16 v[136:139], a[92:95], a[28:31], v[136:139]
    v_mfma_f32_16x16x32_bf16 v[140:143], a[80:83], a[32:35], 0
    v_mfma_f32_16x16x32_bf16 v[140:143], a[84:87], a[36:39], v[140:143]
    v_mfma_f32_16x16x32_bf16 v[140:143], a[88:91], a[40:43], v[140:143]
    v_mfma_f32_16x16x32_bf16 v[140:143], a[92:95], a[44:47], v[140:143]
    v_mfma_f32_16x16x32_bf16 v[144:147], a[96:99], a[0:3], 0
    v_mfma_f32_16x16x32_bf16 v[144:147], a[100:103], a[4:7], v[144:147]
    v_mfma_f32_16x16x32_bf16 v[144:147], a[104:107], a[8:11], v[144:147]
    v_mfma_f32_16x16x32_bf16 v[144:147], a[108:111], a[12:15], v[144:147]
    v_mfma_f32_16x16x32_bf16 v[148:151], a[96:99], a[16:19], 0
    v_mfma_f32_16x16x32_bf16 v[148:151], a[100:103], a[20:23], v[148:151]
    v_mfma_f32_16x16x32_bf16 v[148:151], a[104:107], a[24:27], v[148:151]
    v_mfma_f32_16x16x32_bf16 v[148:151], a[108:111], a[28:31], v[148:151]
    v_mfma_f32_16x16x32_bf16 v[152:155], a[96:99], a[32:35], 0
    v_mfma_f32_16x16x32_bf16 v[152:155], a[100:103], a[36:39], v[152:155]
    v_mfma_f32_16x16x32_bf16 v[152:155], a[104:107], a[40:43], v[152:155]
    v_mfma_f32_16x16x32_bf16 v[152:155], a[108:111], a[44:47], v[152:155]
    v_sub_f32 v108, v108, v216
    v_sub_f32 v109, v109, v216
    v_sub_f32 v110, v110, v216
    v_sub_f32 v111, v111, v216
    v_mul_f32 v108, 0x3e0293ee, v108
    v_mul_f32 v109, 0x3e0293ee, v109
    v_mul_f32 v110, 0x3e0293ee, v110
    v_mul_f32 v111, 0x3e0293ee, v111
    v_exp_f32 v108, v108
    v_exp_f32 v109, v109
    v_exp_f32 v110, v110
    v_exp_f32 v111, v111
    v_sub_f32 v112, v112, v217
    v_sub_f32 v113, v113, v217
    v_sub_f32 v114, v114, v217
    v_sub_f32 v115, v115, v217
    v_mul_f32 v112, 0x3e0293ee, v112
    v_mul_f32 v113, 0x3e0293ee, v113
    v_mul_f32 v114, 0x3e0293ee, v114
    v_mul_f32 v115, 0x3e0293ee, v115
    v_exp_f32 v112, v112
    v_exp_f32 v113, v113
    v_exp_f32 v114, v114
    v_exp_f32 v115, v115
    v_sub_f32 v116, v116, v218
    v_sub_f32 v117, v117, v218
    v_sub_f32 v118, v118, v218
    v_sub_f32 v119, v119, v218
    v_mul_f32 v116, 0x3e0293ee, v116
    v_mul_f32 v117, 0x3e0293ee, v117
    v_mul_f32 v118, 0x3e0293ee, v118
    v_mul_f32 v119, 0x3e0293ee, v119
    v_exp_f32 v116, v116
    v_exp_f32 v117, v117
    v_exp_f32 v118, v118
    v_exp_f32 v119, v119
    v_sub_f32 v120, v120, v216
    v_sub_f32 v121, v121, v216
    v_sub_f32 v122, v122, v216
    v_sub_f32 v123, v123, v216
    v_mul_f32 v120, 0x3e0293ee, v120
    v_mul_f32 v121, 0x3e0293ee, v121
    v_mul_f32 v122, 0x3e0293ee, v122
    v_mul_f32 v123, 0x3e0293ee, v123
    v_exp_f32 v120, v120
    v_exp_f32 v121, v121
    v_exp_f32 v122, v122
    v_exp_f32 v123, v123
    v_sub_f32 v124, v124, v217
    v_sub_f32 v125, v125, v217
    v_sub_f32 v126, v126, v217
    v_sub_f32 v127, v127, v217
    v_mul_f32 v124, 0x3e0293ee, v124
    v_mul_f32 v125, 0x3e0293ee, v125
    v_mul_f32 v126, 0x3e0293ee, v126
    v_mul_f32 v127, 0x3e0293ee, v127
    v_exp_f32 v124, v124
    v_exp_f32 v125, v125
    v_exp_f32 v126, v126
    v_exp_f32 v127, v127
    v_sub_f32 v128, v128, v218
    v_sub_f32 v129, v129, v218
    v_sub_f32 v130, v130, v218
    v_sub_f32 v131, v131, v218
    v_mul_f32 v128, 0x3e0293ee, v128
    v_mul_f32 v129, 0x3e0293ee, v129
    v_mul_f32 v130, 0x3e0293ee, v130
    v_mul_f32 v131, 0x3e0293ee, v131
    v_exp_f32 v128, v128
    v_exp_f32 v129, v129
    v_exp_f32 v130, v130
    v_exp_f32 v131, v131
    v_sub_f32 v132, v132, v216
    v_sub_f32 v133, v133, v216
    v_sub_f32 v134, v134, v216
    v_sub_f32 v135, v135, v216
    v_mul_f32 v132, 0x3e0293ee, v132
    v_mul_f32 v133, 0x3e0293ee, v133
    v_mul_f32 v134, 0x3e0293ee, v134
    v_mul_f32 v135, 0x3e0293ee, v135
    v_exp_f32 v132, v132
    v_exp_f32 v133, v133
    v_exp_f32 v134, v134
    v_exp_f32 v135, v135
    v_sub_f32 v136, v136, v217
    v_sub_f32 v137, v137, v217
    v_sub_f32 v138, v138, v217
    v_sub_f32 v139, v139, v217
    v_mul_f32 v136, 0x3e0293ee, v136
    v_mul_f32 v137, 0x3e0293ee, v137
    v_mul_f32 v138, 0x3e0293ee, v138
    v_mul_f32 v139, 0x3e0293ee, v139
    v_exp_f32 v136, v136
    v_exp_f32 v137, v137
    v_exp_f32 v138, v138
    v_exp_f32 v139, v139
    v_sub_f32 v140, v140, v218
    v_sub_f32 v141, v141, v218
    v_sub_f32 v142, v142, v218
    v_sub_f32 v143, v143, v218
    v_mul_f32 v140, 0x3e0293ee, v140
    v_mul_f32 v141, 0x3e0293ee, v141
    v_mul_f32 v142, 0x3e0293ee, v142
    v_mul_f32 v143, 0x3e0293ee, v143
    v_exp_f32 v140, v140
    v_exp_f32 v141, v141
    v_exp_f32 v142, v142
    v_exp_f32 v143, v143
    v_sub_f32 v144, v144, v216
    v_sub_f32 v145, v145, v216
    v_sub_f32 v146, v146, v216
    v_sub_f32 v147, v147, v216
    v_mul_f32 v144, 0x3e0293ee, v144
    v_mul_f32 v145, 0x3e0293ee, v145
    v_mul_f32 v146, 0x3e0293ee, v146
    v_mul_f32 v147, 0x3e0293ee, v147
    v_exp_f32 v144, v144
    v_exp_f32 v145, v145
    v_exp_f32 v146, v146
    v_exp_f32 v147, v147
    v_sub_f32 v148, v148, v217
    v_sub_f32 v149, v149, v217
    v_sub_f32 v150, v150, v217
    v_sub_f32 v151, v151, v217
    v_mul_f32 v148, 0x3e0293ee, v148
    v_mul_f32 v149, 0x3e0293ee, v149
    v_mul_f32 v150, 0x3e0293ee, v150
    v_mul_f32 v151, 0x3e0293ee, v151
    v_exp_f32 v148, v148
    v_exp_f32 v149, v149
    v_exp_f32 v150, v150
    v_exp_f32 v151, v151
    v_sub_f32 v152, v152, v218
    v_sub_f32 v153, v153, v218
    v_sub_f32 v154, v154, v218
    v_sub_f32 v155, v155, v218
    v_mul_f32 v152, 0x3e0293ee, v152
    v_mul_f32 v153, 0x3e0293ee, v153
    v_mul_f32 v154, 0x3e0293ee, v154
    v_mul_f32 v155, 0x3e0293ee, v155
    v_exp_f32 v152, v152
    v_exp_f32 v153, v153
    v_exp_f32 v154, v154
    v_exp_f32 v155, v155
    v_cvt_pk_bf16_f32 v156, v108, v109
    v_cvt_pk_bf16_f32 v157, v110, v111
    v_cvt_pk_bf16_f32 v164, v112, v113
    v_cvt_pk_bf16_f32 v165, v114, v115
    v_cvt_pk_bf16_f32 v172, v116, v117
    v_cvt_pk_bf16_f32 v173, v118, v119
    v_cvt_pk_bf16_f32 v158, v120, v121
    v_cvt_pk_bf16_f32 v159, v122, v123
    v_cvt_pk_bf16_f32 v166, v124, v125
    v_cvt_pk_bf16_f32 v167, v126, v127
    v_cvt_pk_bf16_f32 v174, v128, v129
    v_cvt_pk_bf16_f32 v175, v130, v131
    v_cvt_pk_bf16_f32 v160, v132, v133
    v_cvt_pk_bf16_f32 v161, v134, v135
    v_cvt_pk_bf16_f32 v168, v136, v137
    v_cvt_pk_bf16_f32 v169, v138, v139
    v_cvt_pk_bf16_f32 v176, v140, v141
    v_cvt_pk_bf16_f32 v177, v142, v143
    v_cvt_pk_bf16_f32 v162, v144, v145
    v_cvt_pk_bf16_f32 v163, v146, v147
    v_cvt_pk_bf16_f32 v170, v148, v149
    v_cvt_pk_bf16_f32 v171, v150, v151
    v_cvt_pk_bf16_f32 v178, v152, v153
    v_cvt_pk_bf16_f32 v179, v154, v155
    s_waitcnt vmcnt(0)
    ds_read_b64_tr_b16 a[112:113], v196 offset:0
    ds_read_b64_tr_b16 a[114:115], v196 offset:1024
    ds_read_b64_tr_b16 a[116:117], v196 offset:2048
    ds_read_b64_tr_b16 a[118:119], v196 offset:3072
    s_waitcnt lgkmcnt(0)
    ds_read_b64_tr_b16 a[120:121], v197 offset:0
    ds_read_b64_tr_b16 a[122:123], v197 offset:1024
    ds_read_b64_tr_b16 a[124:125], v197 offset:2048
    ds_read_b64_tr_b16 a[126:127], v197 offset:3072
    s_waitcnt lgkmcnt(0)
    ds_read_b64_tr_b16 a[128:129], v198 offset:0
    ds_read_b64_tr_b16 a[130:131], v198 offset:1024
    ds_read_b64_tr_b16 a[132:133], v198 offset:2048
    ds_read_b64_tr_b16 a[134:135], v198 offset:3072
    s_waitcnt lgkmcnt(0)
    ds_read_b64_tr_b16 a[136:137], v199 offset:0
    ds_read_b64_tr_b16 a[138:139], v199 offset:1024
    ds_read_b64_tr_b16 a[140:141], v199 offset:2048
    ds_read_b64_tr_b16 a[142:143], v199 offset:3072
    s_waitcnt lgkmcnt(0)
    ds_read_b64_tr_b16 a[144:145], v200 offset:0
    ds_read_b64_tr_b16 a[146:147], v200 offset:1024
    ds_read_b64_tr_b16 a[148:149], v200 offset:2048
    ds_read_b64_tr_b16 a[150:151], v200 offset:3072
    s_waitcnt lgkmcnt(0)
    ds_read_b64_tr_b16 a[152:153], v201 offset:0
    ds_read_b64_tr_b16 a[154:155], v201 offset:1024
    ds_read_b64_tr_b16 a[156:157], v201 offset:2048
    ds_read_b64_tr_b16 a[158:159], v201 offset:3072
    s_waitcnt lgkmcnt(0)
    ds_read_b64_tr_b16 a[160:161], v202 offset:0
    ds_read_b64_tr_b16 a[162:163], v202 offset:1024
    ds_read_b64_tr_b16 a[164:165], v202 offset:2048
    ds_read_b64_tr_b16 a[166:167], v202 offset:3072
    s_waitcnt lgkmcnt(0)
    ds_read_b64_tr_b16 a[168:169], v203 offset:0
    ds_read_b64_tr_b16 a[170:171], v203 offset:1024
    ds_read_b64_tr_b16 a[172:173], v203 offset:2048
    ds_read_b64_tr_b16 a[174:175], v203 offset:3072
    s_waitcnt lgkmcnt(0)
    v_mfma_f32_16x16x32_bf16 v[96:99], a[248:251], v[156:159], v[96:99]
    v_mfma_f32_16x16x32_bf16 v[96:99], a[248:251], v[160:163], v[96:99]
    v_mfma_f32_16x16x32_bf16 v[100:103], a[248:251], v[164:167], v[100:103]
    v_mfma_f32_16x16x32_bf16 v[100:103], a[248:251], v[168:171], v[100:103]
    v_mfma_f32_16x16x32_bf16 v[104:107], a[248:251], v[172:175], v[104:107]
    v_mfma_f32_16x16x32_bf16 v[104:107], a[248:251], v[176:179], v[104:107]
    v_mfma_f32_16x16x32_bf16 v[0:3], a[112:115], v[156:159], v[0:3]
    v_mfma_f32_16x16x32_bf16 v[0:3], a[116:119], v[160:163], v[0:3]
    v_mfma_f32_16x16x32_bf16 v[32:35], a[112:115], v[164:167], v[32:35]
    v_mfma_f32_16x16x32_bf16 v[32:35], a[116:119], v[168:171], v[32:35]
    v_mfma_f32_16x16x32_bf16 v[64:67], a[112:115], v[172:175], v[64:67]
    v_mfma_f32_16x16x32_bf16 v[64:67], a[116:119], v[176:179], v[64:67]
    v_mfma_f32_16x16x32_bf16 v[4:7], a[120:123], v[156:159], v[4:7]
    v_mfma_f32_16x16x32_bf16 v[4:7], a[124:127], v[160:163], v[4:7]
    v_mfma_f32_16x16x32_bf16 v[36:39], a[120:123], v[164:167], v[36:39]
    v_mfma_f32_16x16x32_bf16 v[36:39], a[124:127], v[168:171], v[36:39]
    v_mfma_f32_16x16x32_bf16 v[68:71], a[120:123], v[172:175], v[68:71]
    v_mfma_f32_16x16x32_bf16 v[68:71], a[124:127], v[176:179], v[68:71]
    v_mfma_f32_16x16x32_bf16 v[8:11], a[128:131], v[156:159], v[8:11]
    v_mfma_f32_16x16x32_bf16 v[8:11], a[132:135], v[160:163], v[8:11]
    v_mfma_f32_16x16x32_bf16 v[40:43], a[128:131], v[164:167], v[40:43]
    v_mfma_f32_16x16x32_bf16 v[40:43], a[132:135], v[168:171], v[40:43]
    v_mfma_f32_16x16x32_bf16 v[72:75], a[128:131], v[172:175], v[72:75]
    v_mfma_f32_16x16x32_bf16 v[72:75], a[132:135], v[176:179], v[72:75]
    v_mfma_f32_16x16x32_bf16 v[12:15], a[136:139], v[156:159], v[12:15]
    v_mfma_f32_16x16x32_bf16 v[12:15], a[140:143], v[160:163], v[12:15]
    v_mfma_f32_16x16x32_bf16 v[44:47], a[136:139], v[164:167], v[44:47]
    v_mfma_f32_16x16x32_bf16 v[44:47], a[140:143], v[168:171], v[44:47]
    v_mfma_f32_16x16x32_bf16 v[76:79], a[136:139], v[172:175], v[76:79]
    v_mfma_f32_16x16x32_bf16 v[76:79], a[140:143], v[176:179], v[76:79]
    v_mfma_f32_16x16x32_bf16 v[16:19], a[144:147], v[156:159], v[16:19]
    v_mfma_f32_16x16x32_bf16 v[16:19], a[148:151], v[160:163], v[16:19]
    v_mfma_f32_16x16x32_bf16 v[48:51], a[144:147], v[164:167], v[48:51]
    v_mfma_f32_16x16x32_bf16 v[48:51], a[148:151], v[168:171], v[48:51]
    v_mfma_f32_16x16x32_bf16 v[80:83], a[144:147], v[172:175], v[80:83]
    v_mfma_f32_16x16x32_bf16 v[80:83], a[148:151], v[176:179], v[80:83]
    v_mfma_f32_16x16x32_bf16 v[20:23], a[152:155], v[156:159], v[20:23]
    v_mfma_f32_16x16x32_bf16 v[20:23], a[156:159], v[160:163], v[20:23]
    v_mfma_f32_16x16x32_bf16 v[52:55], a[152:155], v[164:167], v[52:55]
    v_mfma_f32_16x16x32_bf16 v[52:55], a[156:159], v[168:171], v[52:55]
    v_mfma_f32_16x16x32_bf16 v[84:87], a[152:155], v[172:175], v[84:87]
    v_mfma_f32_16x16x32_bf16 v[84:87], a[156:159], v[176:179], v[84:87]
    v_mfma_f32_16x16x32_bf16 v[24:27], a[160:163], v[156:159], v[24:27]
    v_mfma_f32_16x16x32_bf16 v[24:27], a[164:167], v[160:163], v[24:27]
    v_mfma_f32_16x16x32_bf16 v[56:59], a[160:163], v[164:167], v[56:59]
    v_mfma_f32_16x16x32_bf16 v[56:59], a[164:167], v[168:171], v[56:59]
    v_mfma_f32_16x16x32_bf16 v[88:91], a[160:163], v[172:175], v[88:91]
    v_mfma_f32_16x16x32_bf16 v[88:91], a[164:167], v[176:179], v[88:91]
    v_mfma_f32_16x16x32_bf16 v[28:31], a[168:171], v[156:159], v[28:31]
    v_mfma_f32_16x16x32_bf16 v[28:31], a[172:175], v[160:163], v[28:31]
    v_mfma_f32_16x16x32_bf16 v[60:63], a[168:171], v[164:167], v[60:63]
    v_mfma_f32_16x16x32_bf16 v[60:63], a[172:175], v[168:171], v[60:63]
    v_mfma_f32_16x16x32_bf16 v[92:95], a[168:171], v[172:175], v[92:95]
    v_mfma_f32_16x16x32_bf16 v[92:95], a[172:175], v[176:179], v[92:95]
    s_add_u32 s46, s46, 16384
    s_sub_u32 s47, s46, s44
    s_cmp_lt_u32 s47, 131072
    s_nop 15
    s_cbranch_scc1 L_slow2
    v_rcp_f32 v216, v96
    v_rcp_f32 v217, v100
    v_rcp_f32 v218, v104
    s_add_u32 s47, s28, 0
    v_mul_f32 v0, v216, v0
    v_mul_f32 v1, v216, v1
    v_mul_f32 v2, v216, v2
    v_mul_f32 v3, v216, v3
    v_cvt_pk_bf16_f32 v0, v0, v1
    v_cvt_pk_bf16_f32 v1, v2, v3
    ds_write_b64 v210, v[0:1]
    v_mul_f32 v4, v216, v4
    v_mul_f32 v5, v216, v5
    v_mul_f32 v6, v216, v6
    v_mul_f32 v7, v216, v7
    v_cvt_pk_bf16_f32 v4, v4, v5
    v_cvt_pk_bf16_f32 v5, v6, v7
    ds_write_b64 v211, v[4:5]
    v_mul_f32 v8, v216, v8
    v_mul_f32 v9, v216, v9
    v_mul_f32 v10, v216, v10
    v_mul_f32 v11, v216, v11
    v_cvt_pk_bf16_f32 v8, v8, v9
    v_cvt_pk_bf16_f32 v9, v10, v11
    ds_write_b64 v212, v[8:9]
    v_mul_f32 v12, v216, v12
    v_mul_f32 v13, v216, v13
    v_mul_f32 v14, v216, v14
    v_mul_f32 v15, v216, v15
    v_cvt_pk_bf16_f32 v12, v12, v13
    v_cvt_pk_bf16_f32 v13, v14, v15
    ds_write_b64 v213, v[12:13]
    s_waitcnt lgkmcnt(0)
    ds_read_b128 v[108:111], v214 offset:0
    ds_read_b128 v[112:115], v214 offset:1024
    s_waitcnt lgkmcnt(0)
    buffer_store_dwordx4 v[108:111], v215, s[24:27], s47 offen offset:0
    buffer_store_dwordx4 v[112:115], v215, s[24:27], s47 offen offset:2048
    s_waitcnt vmcnt(0)
    v_mul_f32 v16, v216, v16
    v_mul_f32 v17, v216, v17
    v_mul_f32 v18, v216, v18
    v_mul_f32 v19, v216, v19
    v_cvt_pk_bf16_f32 v16, v16, v17
    v_cvt_pk_bf16_f32 v17, v18, v19
    ds_write_b64 v210, v[16:17]
    v_mul_f32 v20, v216, v20
    v_mul_f32 v21, v216, v21
    v_mul_f32 v22, v216, v22
    v_mul_f32 v23, v216, v23
    v_cvt_pk_bf16_f32 v20, v20, v21
    v_cvt_pk_bf16_f32 v21, v22, v23
    ds_write_b64 v211, v[20:21]
    v_mul_f32 v24, v216, v24
    v_mul_f32 v25, v216, v25
    v_mul_f32 v26, v216, v26
    v_mul_f32 v27, v216, v27
    v_cvt_pk_bf16_f32 v24, v24, v25
    v_cvt_pk_bf16_f32 v25, v26, v27
    ds_write_b64 v212, v[24:25]
    v_mul_f32 v28, v216, v28
    v_mul_f32 v29, v216, v29
    v_mul_f32 v30, v216, v30
    v_mul_f32 v31, v216, v31
    v_cvt_pk_bf16_f32 v28, v28, v29
    v_cvt_pk_bf16_f32 v29, v30, v31
    ds_write_b64 v213, v[28:29]
    s_waitcnt lgkmcnt(0)
    ds_read_b128 v[108:111], v214 offset:0
    ds_read_b128 v[112:115], v214 offset:1024
    s_waitcnt lgkmcnt(0)
    buffer_store_dwordx4 v[108:111], v215, s[24:27], s47 offen offset:128
    buffer_store_dwordx4 v[112:115], v215, s[24:27], s47 offen offset:2176
    s_waitcnt vmcnt(0)
    s_add_u32 s47, s28, 16384
    v_mul_f32 v32, v217, v32
    v_mul_f32 v33, v217, v33
    v_mul_f32 v34, v217, v34
    v_mul_f32 v35, v217, v35
    v_cvt_pk_bf16_f32 v32, v32, v33
    v_cvt_pk_bf16_f32 v33, v34, v35
    ds_write_b64 v210, v[32:33]
    v_mul_f32 v36, v217, v36
    v_mul_f32 v37, v217, v37
    v_mul_f32 v38, v217, v38
    v_mul_f32 v39, v217, v39
    v_cvt_pk_bf16_f32 v36, v36, v37
    v_cvt_pk_bf16_f32 v37, v38, v39
    ds_write_b64 v211, v[36:37]
    v_mul_f32 v40, v217, v40
    v_mul_f32 v41, v217, v41
    v_mul_f32 v42, v217, v42
    v_mul_f32 v43, v217, v43
    v_cvt_pk_bf16_f32 v40, v40, v41
    v_cvt_pk_bf16_f32 v41, v42, v43
    ds_write_b64 v212, v[40:41]
    v_mul_f32 v44, v217, v44
    v_mul_f32 v45, v217, v45
    v_mul_f32 v46, v217, v46
    v_mul_f32 v47, v217, v47
    v_cvt_pk_bf16_f32 v44, v44, v45
    v_cvt_pk_bf16_f32 v45, v46, v47
    ds_write_b64 v213, v[44:45]
    s_waitcnt lgkmcnt(0)
    ds_read_b128 v[108:111], v214 offset:0
    ds_read_b128 v[112:115], v214 offset:1024
    s_waitcnt lgkmcnt(0)
    buffer_store_dwordx4 v[108:111], v215, s[24:27], s47 offen offset:0
    buffer_store_dwordx4 v[112:115], v215, s[24:27], s47 offen offset:2048
    s_waitcnt vmcnt(0)
    v_mul_f32 v48, v217, v48
    v_mul_f32 v49, v217, v49
    v_mul_f32 v50, v217, v50
    v_mul_f32 v51, v217, v51
    v_cvt_pk_bf16_f32 v48, v48, v49
    v_cvt_pk_bf16_f32 v49, v50, v51
    ds_write_b64 v210, v[48:49]
    v_mul_f32 v52, v217, v52
    v_mul_f32 v53, v217, v53
    v_mul_f32 v54, v217, v54
    v_mul_f32 v55, v217, v55
    v_cvt_pk_bf16_f32 v52, v52, v53
    v_cvt_pk_bf16_f32 v53, v54, v55
    ds_write_b64 v211, v[52:53]
    v_mul_f32 v56, v217, v56
    v_mul_f32 v57, v217, v57
    v_mul_f32 v58, v217, v58
    v_mul_f32 v59, v217, v59
    v_cvt_pk_bf16_f32 v56, v56, v57
    v_cvt_pk_bf16_f32 v57, v58, v59
    ds_write_b64 v212, v[56:57]
    v_mul_f32 v60, v217, v60
    v_mul_f32 v61, v217, v61
    v_mul_f32 v62, v217, v62
    v_mul_f32 v63, v217, v63
    v_cvt_pk_bf16_f32 v60, v60, v61
    v_cvt_pk_bf16_f32 v61, v62, v63
    ds_write_b64 v213, v[60:61]
    s_waitcnt lgkmcnt(0)
    ds_read_b128 v[108:111], v214 offset:0
    ds_read_b128 v[112:115], v214 offset:1024
    s_waitcnt lgkmcnt(0)
    buffer_store_dwordx4 v[108:111], v215, s[24:27], s47 offen offset:128
    buffer_store_dwordx4 v[112:115], v215, s[24:27], s47 offen offset:2176
    s_waitcnt vmcnt(0)
    s_add_u32 s47, s28, 32768
    v_mul_f32 v64, v218, v64
    v_mul_f32 v65, v218, v65
    v_mul_f32 v66, v218, v66
    v_mul_f32 v67, v218, v67
    v_cvt_pk_bf16_f32 v64, v64, v65
    v_cvt_pk_bf16_f32 v65, v66, v67
    ds_write_b64 v210, v[64:65]
    v_mul_f32 v68, v218, v68
    v_mul_f32 v69, v218, v69
    v_mul_f32 v70, v218, v70
    v_mul_f32 v71, v218, v71
    v_cvt_pk_bf16_f32 v68, v68, v69
    v_cvt_pk_bf16_f32 v69, v70, v71
    ds_write_b64 v211, v[68:69]
    v_mul_f32 v72, v218, v72
    v_mul_f32 v73, v218, v73
    v_mul_f32 v74, v218, v74
    v_mul_f32 v75, v218, v75
    v_cvt_pk_bf16_f32 v72, v72, v73
    v_cvt_pk_bf16_f32 v73, v74, v75
    ds_write_b64 v212, v[72:73]
    v_mul_f32 v76, v218, v76
    v_mul_f32 v77, v218, v77
    v_mul_f32 v78, v218, v78
    v_mul_f32 v79, v218, v79
    v_cvt_pk_bf16_f32 v76, v76, v77
    v_cvt_pk_bf16_f32 v77, v78, v79
    ds_write_b64 v213, v[76:77]
    s_waitcnt lgkmcnt(0)
    ds_read_b128 v[108:111], v214 offset:0
    ds_read_b128 v[112:115], v214 offset:1024
    s_waitcnt lgkmcnt(0)
    buffer_store_dwordx4 v[108:111], v215, s[24:27], s47 offen offset:0
    buffer_store_dwordx4 v[112:115], v215, s[24:27], s47 offen offset:2048
    s_waitcnt vmcnt(0)
    v_mul_f32 v80, v218, v80
    v_mul_f32 v81, v218, v81
    v_mul_f32 v82, v218, v82
    v_mul_f32 v83, v218, v83
    v_cvt_pk_bf16_f32 v80, v80, v81
    v_cvt_pk_bf16_f32 v81, v82, v83
    ds_write_b64 v210, v[80:81]
    v_mul_f32 v84, v218, v84
    v_mul_f32 v85, v218, v85
    v_mul_f32 v86, v218, v86
    v_mul_f32 v87, v218, v87
    v_cvt_pk_bf16_f32 v84, v84, v85
    v_cvt_pk_bf16_f32 v85, v86, v87
    ds_write_b64 v211, v[84:85]
    v_mul_f32 v88, v218, v88
    v_mul_f32 v89, v218, v89
    v_mul_f32 v90, v218, v90
    v_mul_f32 v91, v218, v91
    v_cvt_pk_bf16_f32 v88, v88, v89
    v_cvt_pk_bf16_f32 v89, v90, v91
    ds_write_b64 v212, v[88:89]
    v_mul_f32 v92, v218, v92
    v_mul_f32 v93, v218, v93
    v_mul_f32 v94, v218, v94
    v_mul_f32 v95, v218, v95
    v_cvt_pk_bf16_f32 v92, v92, v93
    v_cvt_pk_bf16_f32 v93, v94, v95
    ds_write_b64 v213, v[92:93]
    s_waitcnt lgkmcnt(0)
    ds_read_b128 v[108:111], v214 offset:0
    ds_read_b128 v[112:115], v214 offset:1024
    s_waitcnt lgkmcnt(0)
    buffer_store_dwordx4 v[108:111], v215, s[24:27], s47 offen offset:128
    buffer_store_dwordx4 v[112:115], v215, s[24:27], s47 offen offset:2176
    s_waitcnt vmcnt(0)
    s_endpgm
.section .rodata,"a"
.p2align 6
.amdhsa_kernel standalone__mha_softmax__near_ridge_kernel
  .amdhsa_next_free_vgpr 512
  .amdhsa_next_free_sgpr 102
  .amdhsa_accum_offset 256
  .amdhsa_group_segment_fixed_size 0
  .amdhsa_kernarg_size 48
  .amdhsa_user_sgpr_count 2
  .amdhsa_user_sgpr_kernarg_segment_ptr 1
  .amdhsa_system_sgpr_workgroup_id_x 1
.end_amdhsa_kernel
```
